```python
import torch

def _softmax(x, axis=-1):
    return torch.softmax(x, dim=axis)
def _gelu(x):
    return torch.nn.functional.gelu(x, approximate="tanh")
def _silu(x):
    return torch.nn.functional.silu(x)
def _sigmoid(x):
    return torch.sigmoid(x)
def _layernorm(x, axis=-1, eps=1e-5):
    m = x.mean(dim=axis, keepdim=True)
    v = x.var(dim=axis, keepdim=True, unbiased=False)
    return (x - m) / torch.sqrt(v + eps)
def _scatter_add(tgt, idx, src, axis=0):
    return tgt.clone().index_add_(axis, idx, src)
def _segment_sum(src, seg, n):
    out = torch.zeros((n,) + src.shape[1:], dtype=src.dtype)
    return out.index_add_(0, seg, src)
def _pad(x, pw):
    flat = tuple(v for pair in reversed(pw) for v in pair)
    return torch.nn.functional.pad(x, flat)

kernel_name = 'interleave_layers__sliding_block_cached__swiglu_ffn__decode'

def setup_inputs():

    _w = (lambda a: (lambda t: t.to(torch.bfloat16) if t.is_floating_point() else t)(torch.as_tensor(a)))
    def _A_setup():
        B, Sq, D = 1, 1, 448
        Hq, Hkv, Sk, Dh = 16, 8, 65536, 256
        assert Hq % Hkv == 0, (Hq, Hkv)
        return {
            "x": _w((lambda *s: torch.randn(*s, dtype=torch.bfloat16) * 0.05)(B, Sq, D)),
            "k_cache": _w((lambda *s: torch.randn(*s, dtype=torch.bfloat16) * 1.6)(B, Hkv, Sk, Dh)),
            "v_cache": _w((lambda *s: torch.randn(*s, dtype=torch.bfloat16) * 1.6)(B, Hkv, Sk, Dh)),
            "wq": _w((lambda *s: torch.randn(*s, dtype=torch.bfloat16) * 1.6)(D, Hq * Dh) * (D ** -0.5)),
            "wo": _w((lambda *s: torch.randn(*s, dtype=torch.bfloat16) * 1.6)(Hq * Dh, D) * ((Hq * Dh) ** -0.5)),
        }
    _A_in = _A_setup()

    def _B_setup():
        B, S, D, F = 1, 1, 448, 1792
        return {
            "x": _w((lambda *s: torch.randn(*s, dtype=torch.bfloat16) * 0.05)(B, S, D)),
            "w_gate": _w((lambda *s: torch.randn(*s, dtype=torch.bfloat16) * 0.05)(D, F)),
            "w_up": _w((lambda *s: torch.randn(*s, dtype=torch.bfloat16) * 0.05)(D, F)),
            "w_down": _w((lambda *s: torch.randn(*s, dtype=torch.bfloat16) * 0.05)(F, D)),
        }
    _B_in = _B_setup()

    return {
        "A_x": _A_in["x"],
        "A_k_cache": _A_in["k_cache"],
        "A_v_cache": _A_in["v_cache"],
        "A_wq": _A_in["wq"],
        "A_wo": _A_in["wo"],
        "B_x": _B_in["x"],
        "B_w_gate": _B_in["w_gate"],
        "B_w_up": _B_in["w_up"],
        "B_w_down": _B_in["w_down"],
    }

def reference(A_x, A_k_cache, A_v_cache, A_wq, A_wo, B_x, B_w_gate, B_w_up, B_w_down):
    def _A_ref(x, k_cache, v_cache, wq, wo):
        B, Sq, D = x.shape
        Hq, Dh = 16, 256
        Hkv, Sk = k_cache.shape[1], k_cache.shape[2]
        W = min(4096, max(256, Sk // 4))
        rep = Hq // Hkv
        q = (lambda x, *d: x.permute(*d))((x @ wq).reshape(B, Sq, Hq, Dh), 0, 2, 1, 3)
        k = (lambda x, n, axis: torch.repeat_interleave(x, n, dim=axis))(k_cache[:, :, Sk - W:, :], rep, axis=1)
        v = (lambda x, n, axis: torch.repeat_interleave(x, n, dim=axis))(v_cache[:, :, Sk - W:, :], rep, axis=1)
        scores = torch.einsum("bhqd,bhkd->bhqk", q, k) * (Dh ** -0.5)
        p = _softmax(scores, axis=-1)
        o = torch.einsum("bhqk,bhkd->bhqd", p, v)
        return (lambda x, *d: x.permute(*d))(o, 0, 2, 1, 3).reshape(B, Sq, Hq * Dh) @ wo

    def _B_ref(x, w_gate, w_up, w_down):
        g = _silu(x @ w_gate)
        u = x @ w_up
        return (g * u) @ w_down

    x = A_x
    x = x + _A_ref(_layernorm(x, axis=-1), A_k_cache, A_v_cache, A_wq, A_wo)
    x = x + _B_ref(_layernorm(x, axis=-1), B_w_gate, B_w_up, B_w_down)
    x = x + _A_ref(_layernorm(x, axis=-1), A_k_cache, A_v_cache, A_wq, A_wo)
    x = x + _B_ref(_layernorm(x, axis=-1), B_w_gate, B_w_up, B_w_down)
    return x
```

```asm
; @launch grid=(256,1,1) block=(512,1,1) lds=75776
.amdgcn_target "amdgcn-amd-amdhsa--gfx950"
.text
.globl interleave_layers__sliding_block_cached__swiglu_ffn__decode_kernel
.p2align 8
.type interleave_layers__sliding_block_cached__swiglu_ffn__decode_kernel,@function
interleave_layers__sliding_block_cached__swiglu_ffn__decode_kernel:
    s_cmp_ge_u32 s2, 256
    s_cbranch_scc1 L_exit
    s_load_dwordx16 s[64:79], s[0:1], 0
    s_load_dwordx8 s[80:87], s[0:1], 64
    v_lshrrev_b32 v1, 6, v0
    v_and_b32 v0, 63, v0
    v_readfirstlane_b32 s3, v1
    v_and_b32 v1, 15, v0
    v_lshrrev_b32 v2, 4, v0

    s_and_b32 s4, s2, 7
    s_lshr_b32 s5, s2, 3
    s_mov_b32 s7, 0
    s_waitcnt lgkmcnt(0)

    s_mov_b32 s8, s86
    s_mov_b32 s9, s87
    s_mov_b32 s10, 8388608
    s_mov_b32 s11, 0x00020000

    s_cmp_lg_u32 s3, 6
    s_cbranch_scc1 L_noreset
    v_mov_b32 v3, 4104
    v_mov_b32 v4, 0
    v_mov_b32 v5, 0
    ds_write_b64 v3, v[4:5]
    ds_write_b64 v3, v[4:5] offset:8
    s_waitcnt lgkmcnt(0)
L_noreset:
    s_load_dword s50, s[86:87], 0
    s_cmp_ge_u32 s3, 4
    s_cbranch_scc1 L_wwave

    s_lshl_b32 s28, s4, 25
    s_lshl_b32 s29, s5, 16
    s_add_u32 s28, s28, s29
    s_lshl_b32 s29, s3, 14
    s_add_u32 s28, s28, s29
    s_add_u32 s28, s28, 31457280

    s_add_u32 s12, s66, s28
    s_addc_u32 s13, s67, 0
    s_mov_b32 s14, 16384
    s_mov_b32 s15, 0x00020000

    s_add_u32 s16, s68, s28
    s_addc_u32 s17, s69, 0
    s_mov_b32 s18, 16384
    s_mov_b32 s19, 0x00020000

    v_lshlrev_b32 v3, 9, v1
    v_lshl_add_u32 v3, v2, 4, v3
    v_lshlrev_b32 v4, 11, v2
    v_lshl_add_u32 v4, v1, 4, v4
    s_movk_i32 s30, 0x2000
    s_barrier

    buffer_load_dwordx4 v[16:19], v3, s[12:15], 0 offen offset:0
    buffer_load_dwordx4 v[20:23], v3, s[12:15], 0 offen offset:64
    buffer_load_dwordx4 v[24:27], v3, s[12:15], 0 offen offset:128
    buffer_load_dwordx4 v[28:31], v3, s[12:15], 0 offen offset:192
    buffer_load_dwordx4 v[32:35], v3, s[12:15], 0 offen offset:256
    buffer_load_dwordx4 v[36:39], v3, s[12:15], 0 offen offset:320
    buffer_load_dwordx4 v[40:43], v3, s[12:15], 0 offen offset:384
    buffer_load_dwordx4 v[44:47], v3, s[12:15], 0 offen offset:448
    buffer_load_dwordx4 v[48:51], v3, s[12:15], s30 offen offset:0
    buffer_load_dwordx4 v[52:55], v3, s[12:15], s30 offen offset:64
    buffer_load_dwordx4 v[56:59], v3, s[12:15], s30 offen offset:128
    buffer_load_dwordx4 v[60:63], v3, s[12:15], s30 offen offset:192
    buffer_load_dwordx4 v[64:67], v3, s[12:15], s30 offen offset:256
    buffer_load_dwordx4 v[68:71], v3, s[12:15], s30 offen offset:320
    buffer_load_dwordx4 v[72:75], v3, s[12:15], s30 offen offset:384
    buffer_load_dwordx4 v[76:79], v3, s[12:15], s30 offen offset:448
    s_cmp_lt_u32 s5, 16
    s_cbranch_scc1 L_qwd_2
    v_mov_b32 v220, 4112
    s_mov_b32 s34, 0
L_qw_1:
    ds_read_b64 v[222:223], v220
    s_waitcnt lgkmcnt(0)
    v_and_b32 v222, v222, v223
    s_nop 0
    v_readfirstlane_b32 s28, v222
    s_cmp_eq_u32 s28, 1
    s_cbranch_scc1 L_qwd_2
    s_sleep 1
    s_add_u32 s34, s34, 1
    s_cmp_lt_u32 s34, 400000
    s_cbranch_scc1 L_qw_1
L_qwd_2:

    buffer_load_dwordx4 v[144:147], v4, s[16:19], 0 offen offset:0
    buffer_load_dwordx4 v[148:151], v4, s[16:19], 0 offen offset:256
    buffer_load_dwordx4 v[152:155], v4, s[16:19], 0 offen offset:512
    buffer_load_dwordx4 v[156:159], v4, s[16:19], 0 offen offset:768
    buffer_load_dwordx4 v[160:163], v4, s[16:19], 0 offen offset:1024
    buffer_load_dwordx4 v[164:167], v4, s[16:19], 0 offen offset:1280
    buffer_load_dwordx4 v[168:171], v4, s[16:19], 0 offen offset:1536
    buffer_load_dwordx4 v[172:175], v4, s[16:19], 0 offen offset:1792
    buffer_load_dwordx4 v[176:179], v4, s[16:19], s30 offen offset:0
    buffer_load_dwordx4 v[180:183], v4, s[16:19], s30 offen offset:256
    buffer_load_dwordx4 v[184:187], v4, s[16:19], s30 offen offset:512
    buffer_load_dwordx4 v[188:191], v4, s[16:19], s30 offen offset:768
    buffer_load_dwordx4 v[192:195], v4, s[16:19], s30 offen offset:1024
    buffer_load_dwordx4 v[196:199], v4, s[16:19], s30 offen offset:1280
    buffer_load_dwordx4 v[200:203], v4, s[16:19], s30 offen offset:1536
    buffer_load_dwordx4 v[204:207], v4, s[16:19], s30 offen offset:1792
    v_lshlrev_b32 v5, 4, v0
    s_lshl_b32 s28, s3, 10
    s_add_u32 s28, s28, 5120
    v_lshlrev_b32 v6, 3, v0
    v_add_u32 v6, s28, v6
    v_lshrrev_b32 v220, 3, v1
    v_lshlrev_b32 v7, 9, v220
    v_lshl_add_u32 v7, v2, 4, v7
    v_add_u32 v7, s28, v7
    s_lshl_b32 s28, s3, 11
    s_add_u32 s28, s28, 9216
    v_lshlrev_b32 v8, 5, v0
    v_add_u32 v8, s28, v8
    s_lshl_b32 s28, s3, 4
    s_add_u32 s28, s28, 17408
    v_lshrrev_b32 v221, 5, v0
    v_lshlrev_b32 v9, 3, v221
    v_add_u32 v9, s28, v9
    s_lshl_b32 s28, s3, 9
    v_lshlrev_b32 v11, 3, v0
    v_add_u32 v11, s28, v11
    v_add_u32 v10, 9216, v11
    s_lshr_b32 s28, s3, 1
    s_lshl_b32 s28, s28, 3
    s_add_u32 s28, s28, 17408
    v_mov_b32 v12, s28
    v_cmp_eq_u32 s[36:37], v220, v221
    v_mov_b32 v216, 0x3f803f80
    v_mov_b32 v217, 0x3f803f80
    v_mov_b32 v218, 0x3f803f80
    v_mov_b32 v219, 0x3f803f80
    s_mov_b32 s38, 0x3db8aa3b
    s_mov_b32 s39, 0x05040100
    s_mov_b32 s44, 0x07060302
    s_mov_b32 s40, 0x01010101
    s_mov_b32 s41, 0x01010101

    s_waitcnt lgkmcnt(0)
    s_mul_i32 s6, s50, 0x9E3779B1
    s_add_u32 s6, s6, 0x7F4A7C15
    s_waitcnt vmcnt(0)
    v_perm_b32 v80, v152, v144, s39
    v_perm_b32 v84, v152, v144, s44
    v_perm_b32 v88, v153, v145, s39
    v_perm_b32 v92, v153, v145, s44
    v_perm_b32 v96, v154, v146, s39
    v_perm_b32 v100, v154, v146, s44
    v_perm_b32 v104, v155, v147, s39
    v_perm_b32 v108, v155, v147, s44
    v_perm_b32 v81, v168, v160, s39
    v_perm_b32 v85, v168, v160, s44
    v_perm_b32 v89, v169, v161, s39
    v_perm_b32 v93, v169, v161, s44
    v_perm_b32 v97, v170, v162, s39
    v_perm_b32 v101, v170, v162, s44
    v_perm_b32 v105, v171, v163, s39
    v_perm_b32 v109, v171, v163, s44
    v_perm_b32 v82, v184, v176, s39
    v_perm_b32 v86, v184, v176, s44
    v_perm_b32 v90, v185, v177, s39
    v_perm_b32 v94, v185, v177, s44
    v_perm_b32 v98, v186, v178, s39
    v_perm_b32 v102, v186, v178, s44
    v_perm_b32 v106, v187, v179, s39
    v_perm_b32 v110, v187, v179, s44
    v_perm_b32 v83, v200, v192, s39
    v_perm_b32 v87, v200, v192, s44
    v_perm_b32 v91, v201, v193, s39
    v_perm_b32 v95, v201, v193, s44
    v_perm_b32 v99, v202, v194, s39
    v_perm_b32 v103, v202, v194, s44
    v_perm_b32 v107, v203, v195, s39
    v_perm_b32 v111, v203, v195, s44
    v_perm_b32 v112, v156, v148, s39
    v_perm_b32 v116, v156, v148, s44
    v_perm_b32 v120, v157, v149, s39
    v_perm_b32 v124, v157, v149, s44
    v_perm_b32 v128, v158, v150, s39
    v_perm_b32 v132, v158, v150, s44
    v_perm_b32 v136, v159, v151, s39
    v_perm_b32 v140, v159, v151, s44
    v_perm_b32 v113, v172, v164, s39
    v_perm_b32 v117, v172, v164, s44
    v_perm_b32 v121, v173, v165, s39
    v_perm_b32 v125, v173, v165, s44
    v_perm_b32 v129, v174, v166, s39
    v_perm_b32 v133, v174, v166, s44
    v_perm_b32 v137, v175, v167, s39
    v_perm_b32 v141, v175, v167, s44
    v_perm_b32 v114, v188, v180, s39
    v_perm_b32 v118, v188, v180, s44
    v_perm_b32 v122, v189, v181, s39
    v_perm_b32 v126, v189, v181, s44
    v_perm_b32 v130, v190, v182, s39
    v_perm_b32 v134, v190, v182, s44
    v_perm_b32 v138, v191, v183, s39
    v_perm_b32 v142, v191, v183, s44
    v_perm_b32 v115, v204, v196, s39
    v_perm_b32 v119, v204, v196, s44
    v_perm_b32 v123, v205, v197, s39
    v_perm_b32 v127, v205, v197, s44
    v_perm_b32 v131, v206, v198, s39
    v_perm_b32 v135, v206, v198, s44
    v_perm_b32 v139, v207, v199, s39
    v_perm_b32 v143, v207, v199, s44
    s_lshl_b32 s28, s4, 11
    s_add_u32 s28, s28, 8192

    s_mov_b32 s34, 0
L_poll_3:
    buffer_load_dwordx4 v[176:179], v5, s[8:11], s28 offen sc1
    buffer_load_dwordx4 v[180:183], v5, s[8:11], s28 offen offset:1024 sc1
    s_waitcnt vmcnt(0)
    v_xor_b32 v220, s6, v177
    v_xor_b32 v221, s6, v179
    v_xor_b32 v222, s6, v181
    v_xor_b32 v223, s6, v183
    v_or3_b32 v220, v220, v221, v222
    v_or_b32 v220, v220, v223
    v_cmp_ne_u32 vcc, 0, v220

    s_cmp_eq_u64 vcc, 0
    s_cbranch_scc1 L_polld_4
    s_sleep 2
    s_add_u32 s34, s34, 1
    s_cmp_lt_u32 s34, 100000
    s_cbranch_scc1 L_poll_3
L_polld_4:

    s_barrier
    ds_write2_b32 v6, v176, v178 offset0:0 offset1:1
    ds_write2_b32 v6, v180, v182 offset0:128 offset1:129
    s_waitcnt lgkmcnt(0)

    ds_read_b128 v[144:147], v7 offset:0
    ds_read_b128 v[148:151], v7 offset:64
    ds_read_b128 v[152:155], v7 offset:128
    ds_read_b128 v[156:159], v7 offset:192
    ds_read_b128 v[160:163], v7 offset:256
    ds_read_b128 v[164:167], v7 offset:320
    ds_read_b128 v[168:171], v7 offset:384
    ds_read_b128 v[172:175], v7 offset:448
    s_waitcnt lgkmcnt(7)
    v_mfma_f32_16x16x32_bf16 v[184:187], v[16:19], v[144:147], 0
    v_mfma_f32_16x16x32_bf16 v[188:191], v[48:51], v[144:147], 0
    s_waitcnt lgkmcnt(6)
    v_mfma_f32_16x16x32_bf16 v[184:187], v[20:23], v[148:151], v[184:187]
    v_mfma_f32_16x16x32_bf16 v[188:191], v[52:55], v[148:151], v[188:191]
    s_waitcnt lgkmcnt(5)
    v_mfma_f32_16x16x32_bf16 v[184:187], v[24:27], v[152:155], v[184:187]
    v_mfma_f32_16x16x32_bf16 v[188:191], v[56:59], v[152:155], v[188:191]
    s_waitcnt lgkmcnt(4)
    v_mfma_f32_16x16x32_bf16 v[184:187], v[28:31], v[156:159], v[184:187]
    v_mfma_f32_16x16x32_bf16 v[188:191], v[60:63], v[156:159], v[188:191]
    s_waitcnt lgkmcnt(3)
    v_mfma_f32_16x16x32_bf16 v[184:187], v[32:35], v[160:163], v[184:187]
    v_mfma_f32_16x16x32_bf16 v[188:191], v[64:67], v[160:163], v[188:191]
    s_waitcnt lgkmcnt(2)
    v_mfma_f32_16x16x32_bf16 v[184:187], v[36:39], v[164:167], v[184:187]
    v_mfma_f32_16x16x32_bf16 v[188:191], v[68:71], v[164:167], v[188:191]
    s_waitcnt lgkmcnt(1)
    v_mfma_f32_16x16x32_bf16 v[184:187], v[40:43], v[168:171], v[184:187]
    v_mfma_f32_16x16x32_bf16 v[188:191], v[72:75], v[168:171], v[188:191]
    s_waitcnt lgkmcnt(0)
    v_mfma_f32_16x16x32_bf16 v[184:187], v[44:47], v[172:175], v[184:187]
    v_mfma_f32_16x16x32_bf16 v[188:191], v[76:79], v[172:175], v[188:191]
    s_nop 7
    v_max3_f32 v224, v184, v185, v186
    v_max3_f32 v224, v224, v187, v188
    v_max3_f32 v224, v224, v189, v190
    v_max_f32 v224, v224, v191
    v_mov_b32 v220, v224
    s_nop 1
    v_permlane16_swap_b32 v224, v220
    s_nop 1
    v_max_f32 v224, v224, v220
    v_mov_b32 v220, v224
    s_nop 1
    v_permlane32_swap_b32 v224, v220
    s_nop 1
    v_max_f32 v224, v224, v220
    v_mul_f32 v224, s38, v224

    v_fma_f32 v226, v184, s38, -v224
    v_fma_f32 v227, v185, s38, -v224
    v_fma_f32 v228, v186, s38, -v224
    v_fma_f32 v229, v187, s38, -v224
    v_fma_f32 v230, v188, s38, -v224
    v_fma_f32 v231, v189, s38, -v224
    v_fma_f32 v232, v190, s38, -v224
    v_fma_f32 v233, v191, s38, -v224
    v_exp_f32 v226, v226
    v_exp_f32 v227, v227
    v_exp_f32 v228, v228
    v_exp_f32 v229, v229
    v_exp_f32 v230, v230
    v_exp_f32 v231, v231
    v_exp_f32 v232, v232
    v_exp_f32 v233, v233
    v_mov_b32_dpp v220, v224 row_ror:8 row_mask:0xf bank_mask:0xf
    v_cvt_pk_bf16_f32 v192, v226, v227
    v_cvt_pk_bf16_f32 v193, v228, v229
    v_cvt_pk_bf16_f32 v194, v230, v231
    v_cvt_pk_bf16_f32 v195, v232, v233
    v_cndmask_b32 v224, v220, v224, s[36:37]
    s_mov_b64 s[42:43], s[40:41]

    v_cndmask_b32 v196, 0, v192, s[42:43]
    v_cndmask_b32 v197, 0, v193, s[42:43]
    v_cndmask_b32 v198, 0, v194, s[42:43]
    v_cndmask_b32 v199, 0, v195, s[42:43]
    s_lshl_b64 s[42:43], s[42:43], 1
    v_mfma_f32_16x16x32_bf16 v[212:215], v[192:195], v[216:219], 0
    s_nop 0
    v_mfma_f32_16x16x32_bf16 v[204:207], v[196:199], v[80:83], 0
    v_mfma_f32_16x16x32_bf16 v[208:211], v[196:199], v[96:99], 0
    v_cndmask_b32 v200, 0, v192, s[42:43]
    v_cndmask_b32 v201, 0, v193, s[42:43]
    v_cndmask_b32 v202, 0, v194, s[42:43]
    v_cndmask_b32 v203, 0, v195, s[42:43]
    s_lshl_b64 s[42:43], s[42:43], 1
    s_nop 0
    v_mfma_f32_16x16x32_bf16 v[204:207], v[200:203], v[84:87], v[204:207]
    v_mfma_f32_16x16x32_bf16 v[208:211], v[200:203], v[100:103], v[208:211]
    v_cndmask_b32 v196, 0, v192, s[42:43]
    v_cndmask_b32 v197, 0, v193, s[42:43]
    v_cndmask_b32 v198, 0, v194, s[42:43]
    v_cndmask_b32 v199, 0, v195, s[42:43]
    s_lshl_b64 s[42:43], s[42:43], 1
    s_nop 0
    v_mfma_f32_16x16x32_bf16 v[204:207], v[196:199], v[88:91], v[204:207]
    v_mfma_f32_16x16x32_bf16 v[208:211], v[196:199], v[104:107], v[208:211]
    v_cndmask_b32 v200, 0, v192, s[42:43]
    v_cndmask_b32 v201, 0, v193, s[42:43]
    v_cndmask_b32 v202, 0, v194, s[42:43]
    v_cndmask_b32 v203, 0, v195, s[42:43]
    s_lshl_b64 s[42:43], s[42:43], 1
    s_nop 0
    v_mfma_f32_16x16x32_bf16 v[204:207], v[200:203], v[92:95], v[204:207]
    v_mfma_f32_16x16x32_bf16 v[208:211], v[200:203], v[108:111], v[208:211]
    v_cndmask_b32 v196, 0, v192, s[42:43]
    v_cndmask_b32 v197, 0, v193, s[42:43]
    v_cndmask_b32 v198, 0, v194, s[42:43]
    v_cndmask_b32 v199, 0, v195, s[42:43]
    s_lshl_b64 s[42:43], s[42:43], 1
    s_nop 0
    v_mfma_f32_16x16x32_bf16 v[204:207], v[196:199], v[112:115], v[204:207]
    v_mfma_f32_16x16x32_bf16 v[208:211], v[196:199], v[128:131], v[208:211]
    v_cndmask_b32 v200, 0, v192, s[42:43]
    v_cndmask_b32 v201, 0, v193, s[42:43]
    v_cndmask_b32 v202, 0, v194, s[42:43]
    v_cndmask_b32 v203, 0, v195, s[42:43]
    s_lshl_b64 s[42:43], s[42:43], 1
    s_nop 0
    v_mfma_f32_16x16x32_bf16 v[204:207], v[200:203], v[116:119], v[204:207]
    v_mfma_f32_16x16x32_bf16 v[208:211], v[200:203], v[132:135], v[208:211]
    v_cndmask_b32 v196, 0, v192, s[42:43]
    v_cndmask_b32 v197, 0, v193, s[42:43]
    v_cndmask_b32 v198, 0, v194, s[42:43]
    v_cndmask_b32 v199, 0, v195, s[42:43]
    s_lshl_b64 s[42:43], s[42:43], 1
    s_nop 0
    v_mfma_f32_16x16x32_bf16 v[204:207], v[196:199], v[120:123], v[204:207]
    v_mfma_f32_16x16x32_bf16 v[208:211], v[196:199], v[136:139], v[208:211]
    v_cndmask_b32 v200, 0, v192, s[42:43]
    v_cndmask_b32 v201, 0, v193, s[42:43]
    v_cndmask_b32 v202, 0, v194, s[42:43]
    v_cndmask_b32 v203, 0, v195, s[42:43]
    s_lshl_b64 s[42:43], s[42:43], 1
    s_nop 0
    v_mfma_f32_16x16x32_bf16 v[204:207], v[200:203], v[124:127], v[204:207]
    v_mfma_f32_16x16x32_bf16 v[208:211], v[200:203], v[140:143], v[208:211]
    v_mov_b32 v225, v212
    s_nop 7
    ds_write_b128 v8, v[204:207]
    ds_write_b128 v8, v[208:211] offset:16
    s_mov_b64 s[32:33], exec
    s_mov_b32 exec_lo, 1
    s_mov_b32 exec_hi, 1
    ds_write_b64 v9, v[224:225]
    s_mov_b64 exec, s[32:33]
    s_waitcnt lgkmcnt(0)

    s_barrier
    ds_read_b64 v[242:243], v12 offset:0
    ds_read_b64 v[244:245], v12 offset:16
    ds_read_b64 v[246:247], v12 offset:32
    ds_read_b64 v[248:249], v12 offset:48
    ds_read_b64 v[234:235], v10 offset:0
    ds_read_b64 v[236:237], v10 offset:2048
    ds_read_b64 v[238:239], v10 offset:4096
    ds_read_b64 v[240:241], v10 offset:6144
    v_mov_b32 v220, 4096
    ds_read_b32 v221, v220 offset:4

    s_waitcnt lgkmcnt(0)
    v_readfirstlane_b32 s7, v221
    v_max3_f32 v224, v242, v244, v246
    v_max_f32 v224, v224, v248
    v_sub_f32 v226, v242, v224
    v_sub_f32 v227, v244, v224
    v_sub_f32 v228, v246, v224
    v_sub_f32 v229, v248, v224
    v_exp_f32 v226, v226
    v_exp_f32 v227, v227
    v_exp_f32 v228, v228
    v_exp_f32 v229, v229
    s_waitcnt lgkmcnt(0)
    v_mul_f32 v220, v226, v234
    v_mul_f32 v221, v226, v235
    v_mul_f32 v225, v226, v243

    v_fmac_f32 v220, v227, v236
    v_fmac_f32 v221, v227, v237
    v_fmac_f32 v225, v227, v245

    v_fmac_f32 v220, v228, v238
    v_fmac_f32 v221, v228, v239
    v_fmac_f32 v225, v228, v247

    v_fmac_f32 v220, v229, v240
    v_fmac_f32 v221, v229, v241
    v_fmac_f32 v225, v229, v249

    s_lshl_b32 s28, s4, 16
    s_lshl_b32 s29, s5, 11
    s_add_u32 s28, s28, s29
    s_add_u32 s28, s28, 1048576

    s_cmp_eq_u32 s7, 0
    s_cbranch_scc1 L_slow_5
    buffer_store_dwordx2 v[220:221], v11, s[8:11], s28 offen
    s_branch L_pubd_6
L_slow_5:
    buffer_store_dwordx2 v[220:221], v11, s[8:11], s28 offen sc1
L_pubd_6:

    s_bitcmp1_b32 s3, 0
    s_cbranch_scc1 L_noml_7
    s_lshl_b32 s28, s4, 9
    s_lshl_b32 s29, s5, 4
    s_add_u32 s28, s28, s29
    s_lshl_b32 s29, s3, 2
    s_add_u32 s28, s28, s29
    s_add_u32 s28, s28, 40960
    v_mov_b32 v222, 0
    s_mov_b64 s[32:33], exec
    s_mov_b64 exec, 1

    s_cmp_eq_u32 s7, 0
    s_cbranch_scc1 L_slow_8
    buffer_store_dwordx2 v[224:225], v222, s[8:11], s28 offen
    s_branch L_pubd_9
L_slow_8:
    buffer_store_dwordx2 v[224:225], v222, s[8:11], s28 offen sc1
L_pubd_9:

    s_mov_b64 exec, s[32:33]
L_noml_7:

    s_barrier
    s_barrier
    s_barrier
    s_barrier
    s_lshl_b32 s28, s4, 11
    s_add_u32 s28, s28, 24576

    s_mov_b32 s34, 0
L_poll_10:
    buffer_load_dwordx4 v[176:179], v5, s[8:11], s28 offen sc1
    buffer_load_dwordx4 v[180:183], v5, s[8:11], s28 offen offset:1024 sc1
    s_waitcnt vmcnt(0)
    v_xor_b32 v220, s6, v177
    v_xor_b32 v221, s6, v179
    v_xor_b32 v222, s6, v181
    v_xor_b32 v223, s6, v183
    v_or3_b32 v220, v220, v221, v222
    v_or_b32 v220, v220, v223
    v_cmp_ne_u32 vcc, 0, v220

    s_cmp_eq_u64 vcc, 0
    s_cbranch_scc1 L_polld_11

    s_add_u32 s34, s34, 1
    s_cmp_lt_u32 s34, 100000
    s_cbranch_scc1 L_poll_10
L_polld_11:

    ds_write2_b32 v6, v176, v178 offset0:0 offset1:1
    ds_write2_b32 v6, v180, v182 offset0:128 offset1:129
    s_waitcnt lgkmcnt(0)

    ds_read_b128 v[144:147], v7 offset:0
    ds_read_b128 v[148:151], v7 offset:64
    ds_read_b128 v[152:155], v7 offset:128
    ds_read_b128 v[156:159], v7 offset:192
    ds_read_b128 v[160:163], v7 offset:256
    ds_read_b128 v[164:167], v7 offset:320
    ds_read_b128 v[168:171], v7 offset:384
    ds_read_b128 v[172:175], v7 offset:448
    s_waitcnt lgkmcnt(7)
    v_mfma_f32_16x16x32_bf16 v[184:187], v[16:19], v[144:147], 0
    v_mfma_f32_16x16x32_bf16 v[188:191], v[48:51], v[144:147], 0
    s_waitcnt lgkmcnt(6)
    v_mfma_f32_16x16x32_bf16 v[184:187], v[20:23], v[148:151], v[184:187]
    v_mfma_f32_16x16x32_bf16 v[188:191], v[52:55], v[148:151], v[188:191]
    s_waitcnt lgkmcnt(5)
    v_mfma_f32_16x16x32_bf16 v[184:187], v[24:27], v[152:155], v[184:187]
    v_mfma_f32_16x16x32_bf16 v[188:191], v[56:59], v[152:155], v[188:191]
    s_waitcnt lgkmcnt(4)
    v_mfma_f32_16x16x32_bf16 v[184:187], v[28:31], v[156:159], v[184:187]
    v_mfma_f32_16x16x32_bf16 v[188:191], v[60:63], v[156:159], v[188:191]
    s_waitcnt lgkmcnt(3)
    v_mfma_f32_16x16x32_bf16 v[184:187], v[32:35], v[160:163], v[184:187]
    v_mfma_f32_16x16x32_bf16 v[188:191], v[64:67], v[160:163], v[188:191]
    s_waitcnt lgkmcnt(2)
    v_mfma_f32_16x16x32_bf16 v[184:187], v[36:39], v[164:167], v[184:187]
    v_mfma_f32_16x16x32_bf16 v[188:191], v[68:71], v[164:167], v[188:191]
    s_waitcnt lgkmcnt(1)
    v_mfma_f32_16x16x32_bf16 v[184:187], v[40:43], v[168:171], v[184:187]
    v_mfma_f32_16x16x32_bf16 v[188:191], v[72:75], v[168:171], v[188:191]
    s_waitcnt lgkmcnt(0)
    v_mfma_f32_16x16x32_bf16 v[184:187], v[44:47], v[172:175], v[184:187]
    v_mfma_f32_16x16x32_bf16 v[188:191], v[76:79], v[172:175], v[188:191]
    s_nop 7
    v_max3_f32 v224, v184, v185, v186
    v_max3_f32 v224, v224, v187, v188
    v_max3_f32 v224, v224, v189, v190
    v_max_f32 v224, v224, v191
    v_mov_b32 v220, v224
    s_nop 1
    v_permlane16_swap_b32 v224, v220
    s_nop 1
    v_max_f32 v224, v224, v220
    v_mov_b32 v220, v224
    s_nop 1
    v_permlane32_swap_b32 v224, v220
    s_nop 1
    v_max_f32 v224, v224, v220
    v_mul_f32 v224, s38, v224

    v_fma_f32 v226, v184, s38, -v224
    v_fma_f32 v227, v185, s38, -v224
    v_fma_f32 v228, v186, s38, -v224
    v_fma_f32 v229, v187, s38, -v224
    v_fma_f32 v230, v188, s38, -v224
    v_fma_f32 v231, v189, s38, -v224
    v_fma_f32 v232, v190, s38, -v224
    v_fma_f32 v233, v191, s38, -v224
    v_exp_f32 v226, v226
    v_exp_f32 v227, v227
    v_exp_f32 v228, v228
    v_exp_f32 v229, v229
    v_exp_f32 v230, v230
    v_exp_f32 v231, v231
    v_exp_f32 v232, v232
    v_exp_f32 v233, v233
    v_mov_b32_dpp v220, v224 row_ror:8 row_mask:0xf bank_mask:0xf
    v_cvt_pk_bf16_f32 v192, v226, v227
    v_cvt_pk_bf16_f32 v193, v228, v229
    v_cvt_pk_bf16_f32 v194, v230, v231
    v_cvt_pk_bf16_f32 v195, v232, v233
    v_cndmask_b32 v224, v220, v224, s[36:37]
    s_mov_b64 s[42:43], s[40:41]

    v_cndmask_b32 v196, 0, v192, s[42:43]
    v_cndmask_b32 v197, 0, v193, s[42:43]
    v_cndmask_b32 v198, 0, v194, s[42:43]
    v_cndmask_b32 v199, 0, v195, s[42:43]
    s_lshl_b64 s[42:43], s[42:43], 1
    v_mfma_f32_16x16x32_bf16 v[212:215], v[192:195], v[216:219], 0
    s_nop 0
    v_mfma_f32_16x16x32_bf16 v[204:207], v[196:199], v[80:83], 0
    v_mfma_f32_16x16x32_bf16 v[208:211], v[196:199], v[96:99], 0
    v_cndmask_b32 v200, 0, v192, s[42:43]
    v_cndmask_b32 v201, 0, v193, s[42:43]
    v_cndmask_b32 v202, 0, v194, s[42:43]
    v_cndmask_b32 v203, 0, v195, s[42:43]
    s_lshl_b64 s[42:43], s[42:43], 1
    s_nop 0
    v_mfma_f32_16x16x32_bf16 v[204:207], v[200:203], v[84:87], v[204:207]
    v_mfma_f32_16x16x32_bf16 v[208:211], v[200:203], v[100:103], v[208:211]
    v_cndmask_b32 v196, 0, v192, s[42:43]
    v_cndmask_b32 v197, 0, v193, s[42:43]
    v_cndmask_b32 v198, 0, v194, s[42:43]
    v_cndmask_b32 v199, 0, v195, s[42:43]
    s_lshl_b64 s[42:43], s[42:43], 1
    s_nop 0
    v_mfma_f32_16x16x32_bf16 v[204:207], v[196:199], v[88:91], v[204:207]
    v_mfma_f32_16x16x32_bf16 v[208:211], v[196:199], v[104:107], v[208:211]
    v_cndmask_b32 v200, 0, v192, s[42:43]
    v_cndmask_b32 v201, 0, v193, s[42:43]
    v_cndmask_b32 v202, 0, v194, s[42:43]
    v_cndmask_b32 v203, 0, v195, s[42:43]
    s_lshl_b64 s[42:43], s[42:43], 1
    s_nop 0
    v_mfma_f32_16x16x32_bf16 v[204:207], v[200:203], v[92:95], v[204:207]
    v_mfma_f32_16x16x32_bf16 v[208:211], v[200:203], v[108:111], v[208:211]
    v_cndmask_b32 v196, 0, v192, s[42:43]
    v_cndmask_b32 v197, 0, v193, s[42:43]
    v_cndmask_b32 v198, 0, v194, s[42:43]
    v_cndmask_b32 v199, 0, v195, s[42:43]
    s_lshl_b64 s[42:43], s[42:43], 1
    s_nop 0
    v_mfma_f32_16x16x32_bf16 v[204:207], v[196:199], v[112:115], v[204:207]
    v_mfma_f32_16x16x32_bf16 v[208:211], v[196:199], v[128:131], v[208:211]
    v_cndmask_b32 v200, 0, v192, s[42:43]
    v_cndmask_b32 v201, 0, v193, s[42:43]
    v_cndmask_b32 v202, 0, v194, s[42:43]
    v_cndmask_b32 v203, 0, v195, s[42:43]
    s_lshl_b64 s[42:43], s[42:43], 1
    s_nop 0
    v_mfma_f32_16x16x32_bf16 v[204:207], v[200:203], v[116:119], v[204:207]
    v_mfma_f32_16x16x32_bf16 v[208:211], v[200:203], v[132:135], v[208:211]
    v_cndmask_b32 v196, 0, v192, s[42:43]
    v_cndmask_b32 v197, 0, v193, s[42:43]
    v_cndmask_b32 v198, 0, v194, s[42:43]
    v_cndmask_b32 v199, 0, v195, s[42:43]
    s_lshl_b64 s[42:43], s[42:43], 1
    s_nop 0
    v_mfma_f32_16x16x32_bf16 v[204:207], v[196:199], v[120:123], v[204:207]
    v_mfma_f32_16x16x32_bf16 v[208:211], v[196:199], v[136:139], v[208:211]
    v_cndmask_b32 v200, 0, v192, s[42:43]
    v_cndmask_b32 v201, 0, v193, s[42:43]
    v_cndmask_b32 v202, 0, v194, s[42:43]
    v_cndmask_b32 v203, 0, v195, s[42:43]
    s_lshl_b64 s[42:43], s[42:43], 1
    s_nop 0
    v_mfma_f32_16x16x32_bf16 v[204:207], v[200:203], v[124:127], v[204:207]
    v_mfma_f32_16x16x32_bf16 v[208:211], v[200:203], v[140:143], v[208:211]
    v_mov_b32 v225, v212
    s_nop 7
    ds_write_b128 v8, v[204:207]
    ds_write_b128 v8, v[208:211] offset:16
    s_mov_b64 s[32:33], exec
    s_mov_b32 exec_lo, 1
    s_mov_b32 exec_hi, 1
    ds_write_b64 v9, v[224:225]
    s_mov_b64 exec, s[32:33]
    s_waitcnt lgkmcnt(0)

    s_barrier
    ds_read_b64 v[242:243], v12 offset:0
    ds_read_b64 v[244:245], v12 offset:16
    ds_read_b64 v[246:247], v12 offset:32
    ds_read_b64 v[248:249], v12 offset:48
    ds_read_b64 v[234:235], v10 offset:0
    ds_read_b64 v[236:237], v10 offset:2048
    ds_read_b64 v[238:239], v10 offset:4096
    ds_read_b64 v[240:241], v10 offset:6144
    s_waitcnt lgkmcnt(4)
    v_max3_f32 v224, v242, v244, v246
    v_max_f32 v224, v224, v248
    v_sub_f32 v226, v242, v224
    v_sub_f32 v227, v244, v224
    v_sub_f32 v228, v246, v224
    v_sub_f32 v229, v248, v224
    v_exp_f32 v226, v226
    v_exp_f32 v227, v227
    v_exp_f32 v228, v228
    v_exp_f32 v229, v229
    s_waitcnt lgkmcnt(0)
    v_mul_f32 v220, v226, v234
    v_mul_f32 v221, v226, v235
    v_mul_f32 v225, v226, v243

    v_fmac_f32 v220, v227, v236
    v_fmac_f32 v221, v227, v237
    v_fmac_f32 v225, v227, v245

    v_fmac_f32 v220, v228, v238
    v_fmac_f32 v221, v228, v239
    v_fmac_f32 v225, v228, v247

    v_fmac_f32 v220, v229, v240
    v_fmac_f32 v221, v229, v241
    v_fmac_f32 v225, v229, v249

    s_lshl_b32 s28, s4, 16
    s_lshl_b32 s29, s5, 11
    s_add_u32 s28, s28, s29
    s_add_u32 s28, s28, 1572864

    s_cmp_eq_u32 s7, 0
    s_cbranch_scc1 L_slow_12
    buffer_store_dwordx2 v[220:221], v11, s[8:11], s28 offen
    s_branch L_pubd_13
L_slow_12:
    buffer_store_dwordx2 v[220:221], v11, s[8:11], s28 offen sc1
L_pubd_13:

    s_bitcmp1_b32 s3, 0
    s_cbranch_scc1 L_noml_14
    s_lshl_b32 s28, s4, 9
    s_lshl_b32 s29, s5, 4
    s_add_u32 s28, s28, s29
    s_lshl_b32 s29, s3, 2
    s_add_u32 s28, s28, s29
    s_add_u32 s28, s28, 45056
    v_mov_b32 v222, 0
    s_mov_b64 s[32:33], exec
    s_mov_b64 exec, 1

    s_cmp_eq_u32 s7, 0
    s_cbranch_scc1 L_slow_15
    buffer_store_dwordx2 v[224:225], v222, s[8:11], s28 offen
    s_branch L_pubd_16
L_slow_15:
    buffer_store_dwordx2 v[224:225], v222, s[8:11], s28 offen sc1
L_pubd_16:

    s_mov_b64 exec, s[32:33]
L_noml_14:

    s_endpgm
L_wwave:
    s_sub_u32 s35, s3, 4
    v_cmp_gt_u32 s[36:37], 56, v0
    s_mul_i32 s28, s35, 448
    v_lshlrev_b32 v3, 3, v0
    v_add_u32 v3, s28, v3
    v_lshrrev_b32 v4, 1, v3
    v_lshlrev_b32 v6, 4, v0

    s_mov_b32 s12, s64
    s_mov_b32 s13, s65
    s_mov_b32 s14, 896
    s_mov_b32 s15, 0x00020000

    s_mov_b32 s20, s82
    s_mov_b32 s21, s83
    s_mov_b32 s22, 896
    s_mov_b32 s23, 0x00020000

    s_cmp_ge_u32 s5, 16
    s_cbranch_scc1 L_roleF_17

    s_and_b32 s32, s35, 1
    s_lshl_b32 s33, s5, 1
    s_add_u32 s33, s33, s32
    s_cmp_eq_u32 s35, 3
    s_cbranch_scc1 L_r3_19

    s_cmp_eq_u32 s35, 2
    s_cbranch_scc1 L_rw2_21
    s_lshl_b32 s28, s4, 9
    s_lshl_b32 s29, s5, 5
    s_add_u32 s28, s28, s29
    s_lshl_b32 s29, s35, 4
    s_add_u32 s28, s28, s29
    s_mul_i32 s28, s28, 896

    s_add_u32 s24, s72, s28
    s_addc_u32 s25, s73, 0
    s_mov_b32 s26, 14336
    s_mov_b32 s27, 0x00020000

    s_mul_i32 s28, s35, 14336
    s_add_u32 s28, s28, 47104
    v_add_u32 v254, s28, v6
    s_mov_b64 exec, s[36:37]

    s_movk_i32 s28, 0
    buffer_load_dwordx4 v[72:75], v6, s[24:27], s28 offen
    s_movk_i32 s28, 896
    buffer_load_dwordx4 v[76:79], v6, s[24:27], s28 offen
    s_movk_i32 s28, 1792
    buffer_load_dwordx4 v[80:83], v6, s[24:27], s28 offen
    s_movk_i32 s28, 2688
    buffer_load_dwordx4 v[84:87], v6, s[24:27], s28 offen
    s_movk_i32 s28, 3584
    buffer_load_dwordx4 v[88:91], v6, s[24:27], s28 offen
    s_movk_i32 s28, 4480
    buffer_load_dwordx4 v[92:95], v6, s[24:27], s28 offen
    s_movk_i32 s28, 5376
    buffer_load_dwordx4 v[96:99], v6, s[24:27], s28 offen
    s_movk_i32 s28, 6272
    buffer_load_dwordx4 v[100:103], v6, s[24:27], s28 offen
    s_movk_i32 s28, 7168
    buffer_load_dwordx4 v[104:107], v6, s[24:27], s28 offen
    s_movk_i32 s28, 8064
    buffer_load_dwordx4 v[108:111], v6, s[24:27], s28 offen
    s_movk_i32 s28, 8960
    buffer_load_dwordx4 v[112:115], v6, s[24:27], s28 offen
    s_movk_i32 s28, 9856
    buffer_load_dwordx4 v[116:119], v6, s[24:27], s28 offen
    s_movk_i32 s28, 10752
    buffer_load_dwordx4 v[120:123], v6, s[24:27], s28 offen
    s_movk_i32 s28, 11648
    buffer_load_dwordx4 v[124:127], v6, s[24:27], s28 offen
    s_movk_i32 s28, 12544
    buffer_load_dwordx4 v[128:131], v6, s[24:27], s28 offen
    s_movk_i32 s28, 13440
    buffer_load_dwordx4 v[132:135], v6, s[24:27], s28 offen
    s_mov_b64 exec, -1
    s_barrier

    v_lshlrev_b32 v5, 4, v2
    v_lshrrev_b32 v250, 2, v1
    v_lshl_add_u32 v250, v2, 3, v250
    v_lshlrev_b32 v7, 5, v250
    v_and_b32 v250, 3, v1
    v_lshl_add_u32 v7, v250, 3, v7
    s_mul_i32 s28, s32, 14336
    s_add_u32 s28, s28, 18432
    v_add_u32 v7, s28, v7
    v_lshlrev_b32 v8, 11, v1
    v_lshl_add_u32 v8, v2, 4, v8
    v_lshlrev_b32 v9, 4, v1
    v_and_b32 v250, 1, v1
    v_lshl_add_u32 v250, v2, 1, v250
    v_lshlrev_b32 v13, 4, v250
    v_lshrrev_b32 v251, 1, v1
    v_lshl_add_u32 v12, v251, 11, v13
    v_lshl_add_u32 v10, v251, 14, v13
    v_lshl_add_u32 v11, v251, 7, v13
    v_mov_b32 v240, 0x3f803f80
    v_mov_b32 v241, 0x3f803f80
    v_mov_b32 v242, 0x3f803f80
    v_mov_b32 v243, 0x3f803f80
    s_mov_b32 s45, 0x3b124925
    s_mov_b32 s48, 0x3727c5ac
    s_mov_b32 s49, 0xbfb8aa3b

    s_mov_b64 exec, s[36:37]
    s_waitcnt vmcnt(15)
    ds_write_b128 v254, v[72:75] offset:0
    s_waitcnt vmcnt(14)
    ds_write_b128 v254, v[76:79] offset:896
    s_waitcnt vmcnt(13)
    ds_write_b128 v254, v[80:83] offset:1792
    s_waitcnt vmcnt(12)
    ds_write_b128 v254, v[84:87] offset:2688
    s_waitcnt vmcnt(11)
    ds_write_b128 v254, v[88:91] offset:3584
    s_waitcnt vmcnt(10)
    ds_write_b128 v254, v[92:95] offset:4480
    s_waitcnt vmcnt(9)
    ds_write_b128 v254, v[96:99] offset:5376
    s_waitcnt vmcnt(8)
    ds_write_b128 v254, v[100:103] offset:6272
    s_waitcnt lgkmcnt(0)
    s_waitcnt vmcnt(7)
    ds_write_b128 v254, v[104:107] offset:7168
    s_waitcnt vmcnt(6)
    ds_write_b128 v254, v[108:111] offset:8064
    s_waitcnt vmcnt(5)
    ds_write_b128 v254, v[112:115] offset:8960
    s_waitcnt vmcnt(4)
    ds_write_b128 v254, v[116:119] offset:9856
    s_waitcnt vmcnt(3)
    ds_write_b128 v254, v[120:123] offset:10752
    s_waitcnt vmcnt(2)
    ds_write_b128 v254, v[124:127] offset:11648
    s_waitcnt vmcnt(1)
    ds_write_b128 v254, v[128:131] offset:12544
    s_waitcnt vmcnt(0)
    ds_write_b128 v254, v[132:135] offset:13440
    s_waitcnt lgkmcnt(0)
    s_mov_b64 exec, -1
    s_branch L_rj_20
L_rw2_21:
    s_barrier

    v_lshlrev_b32 v5, 4, v2
    v_lshrrev_b32 v250, 2, v1
    v_lshl_add_u32 v250, v2, 3, v250
    v_lshlrev_b32 v7, 5, v250
    v_and_b32 v250, 3, v1
    v_lshl_add_u32 v7, v250, 3, v7
    s_mul_i32 s28, s32, 14336
    s_add_u32 s28, s28, 18432
    v_add_u32 v7, s28, v7
    v_lshlrev_b32 v8, 11, v1
    v_lshl_add_u32 v8, v2, 4, v8
    v_lshlrev_b32 v9, 4, v1
    v_and_b32 v250, 1, v1
    v_lshl_add_u32 v250, v2, 1, v250
    v_lshlrev_b32 v13, 4, v250
    v_lshrrev_b32 v251, 1, v1
    v_lshl_add_u32 v12, v251, 11, v13
    v_lshl_add_u32 v10, v251, 14, v13
    v_lshl_add_u32 v11, v251, 7, v13
    v_mov_b32 v240, 0x3f803f80
    v_mov_b32 v241, 0x3f803f80
    v_mov_b32 v242, 0x3f803f80
    v_mov_b32 v243, 0x3f803f80
    s_mov_b32 s45, 0x3b124925
    s_mov_b32 s48, 0x3727c5ac
    s_mov_b32 s49, 0xbfb8aa3b

    s_lshl_b32 s28, s5, 6
    v_lshrrev_b32 v250, 1, v13
    buffer_load_dwordx2 v[18:19], v250, s[12:15], s28 offen
    s_waitcnt vmcnt(0)
    v_lshlrev_b32 v16, 16, v18
    v_and_b32 v17, 0xffff0000, v18
    v_lshlrev_b32 v18, 16, v19
    v_and_b32 v19, 0xffff0000, v19
    s_branch L_rj_20
L_r3_19:

    v_mov_b32 v176, -1
    v_mov_b32 v177, -1
    v_mov_b32 v178, -1
    v_mov_b32 v179, -1
    s_lshl_b32 s28, s4, 16
    s_lshl_b32 s29, s5, 11
    s_add_u32 s28, s28, s29

    s_add_u32 s29, s28, 1048576
    buffer_store_dwordx4 v[176:179], v6, s[8:11], s29 offen sc1
    buffer_store_dwordx4 v[176:179], v6, s[8:11], s29 offen offset:1024 sc1
    s_add_u32 s29, s28, 1572864
    buffer_store_dwordx4 v[176:179], v6, s[8:11], s29 offen sc1
    buffer_store_dwordx4 v[176:179], v6, s[8:11], s29 offen offset:1024 sc1
    s_add_u32 s29, s28, 2097152
    buffer_store_dwordx4 v[176:179], v6, s[8:11], s29 offen sc1
    buffer_store_dwordx4 v[176:179], v6, s[8:11], s29 offen offset:1024 sc1
    s_add_u32 s29, s28, 3145728
    buffer_store_dwordx4 v[176:179], v6, s[8:11], s29 offen sc1
    buffer_store_dwordx4 v[176:179], v6, s[8:11], s29 offen offset:1024 sc1
    s_lshl_b32 s28, s4, 9
    s_lshl_b32 s29, s5, 4
    s_add_u32 s28, s28, s29
    s_mov_b64 exec, 1

    s_add_u32 s29, s28, 40960
    buffer_store_dwordx4 v[176:179], v6, s[8:11], s29 offen sc1
    s_add_u32 s29, s28, 45056
    buffer_store_dwordx4 v[176:179], v6, s[8:11], s29 offen sc1
    s_cmp_ge_u32 s5, 14
    s_cbranch_scc1 L_noz_23
    s_mov_b64 exec, -1
    v_lshrrev_b32 v250, 3, v0
    v_lshlrev_b32 v250, 14, v250
    v_and_b32 v251, 7, v0
    v_lshl_add_u32 v250, v251, 4, v250
    s_lshl_b32 s28, s4, 7
    s_lshl_b32 s29, s5, 10
    s_add_u32 s28, s28, s29

    s_add_u32 s29, s28, 262144
    buffer_store_dwordx4 v[176:179], v250, s[8:11], s29 offen sc1
    s_add_u32 s29, s28, 393216
    buffer_store_dwordx4 v[176:179], v250, s[8:11], s29 offen sc1
    s_add_u32 s29, s28, 524288
    buffer_store_dwordx4 v[176:179], v250, s[8:11], s29 offen sc1
    s_add_u32 s29, s28, 655360
    buffer_store_dwordx4 v[176:179], v250, s[8:11], s29 offen sc1
    s_mov_b64 exec, 0xf
    s_lshl_b32 s28, s4, 10
    s_lshl_b32 s29, s5, 6
    s_add_u32 s28, s28, s29

    s_add_u32 s29, s28, 131072
    buffer_store_dwordx4 v[176:179], v6, s[8:11], s29 offen sc1
    s_add_u32 s29, s28, 139264
    buffer_store_dwordx4 v[176:179], v6, s[8:11], s29 offen sc1
    s_add_u32 s29, s28, 147456
    buffer_store_dwordx4 v[176:179], v6, s[8:11], s29 offen sc1
L_noz_23:
    s_mov_b64 exec, -1
    s_barrier
    v_lshlrev_b32 v5, 4, v2
    v_lshrrev_b32 v250, 2, v1
    v_lshl_add_u32 v250, v2, 3, v250
    v_lshlrev_b32 v7, 5, v250
    v_and_b32 v250, 3, v1
    v_lshl_add_u32 v7, v250, 3, v7
    s_mul_i32 s28, s32, 14336
    s_add_u32 s28, s28, 18432
    v_add_u32 v7, s28, v7
    v_lshlrev_b32 v8, 11, v1
    v_lshl_add_u32 v8, v2, 4, v8
    v_lshlrev_b32 v9, 4, v1
    v_and_b32 v250, 1, v1
    v_lshl_add_u32 v250, v2, 1, v250
    v_lshlrev_b32 v13, 4, v250
    v_lshrrev_b32 v251, 1, v1
    v_lshl_add_u32 v12, v251, 11, v13
    v_lshl_add_u32 v10, v251, 14, v13
    v_lshl_add_u32 v11, v251, 7, v13
    v_mov_b32 v240, 0x3f803f80
    v_mov_b32 v241, 0x3f803f80
    v_mov_b32 v242, 0x3f803f80
    v_mov_b32 v243, 0x3f803f80
    s_mov_b32 s45, 0x3b124925
    s_mov_b32 s48, 0x3727c5ac
    s_mov_b32 s49, 0xbfb8aa3b

    s_waitcnt lgkmcnt(0)
    s_mul_i32 s6, s50, 0x9E3779B1
    s_add_u32 s6, s6, 0x7F4A7C15
    s_getreg_b32 s51, hwreg(HW_REG_XCC_ID)
    s_and_b32 s51, s51, 15
    s_or_b32 s51, s51, 0x100
    v_mov_b32 v14, s51
    v_mov_b32 v15, s6
    v_mov_b32 v250, 0
    s_lshl_b32 s28, s2, 3
    s_add_u32 s28, s28, 4096
    s_waitcnt vmcnt(0)
    s_mov_b64 exec, 1
    buffer_store_dwordx2 v[14:15], v250, s[8:11], s28 offen sc1
    s_mov_b64 exec, -1

L_rj_20:
    s_waitcnt lgkmcnt(0)
    s_barrier
    s_cmp_lg_u32 s35, 3
    s_cbranch_scc1 L_only_24

    s_movk_i32 s28, 4096
    s_mov_b32 s34, 0
L_poll_25:
    buffer_load_dwordx4 v[176:179], v6, s[8:11], s28 offen sc1
    buffer_load_dwordx4 v[180:183], v6, s[8:11], s28 offen offset:1024 sc1
    s_waitcnt vmcnt(0)
    v_xor_b32 v250, s6, v177
    v_xor_b32 v251, s6, v179
    v_xor_b32 v252, s6, v181
    v_xor_b32 v253, s6, v183
    v_or3_b32 v250, v250, v251, v252
    v_or_b32 v250, v250, v253
    v_cmp_ne_u32 vcc, 0, v250

    s_cmp_eq_u64 vcc, 0
    s_cbranch_scc1 L_polld_26
    s_sleep 2
    s_add_u32 s34, s34, 1
    s_cmp_lt_u32 s34, 100000
    s_cbranch_scc1 L_poll_25
L_polld_26:

    v_lshlrev_b32 v250, 1, v0
    v_and_b32 v250, 7, v250
    v_or_b32 v251, 1, v250
    v_cmp_eq_u32 s[52:53], s4, v250
    v_cmp_eq_u32 s[54:55], s4, v251
    v_cmp_ne_u32 s[56:57], s51, v176
    v_cmp_ne_u32 s[58:59], s51, v180
    v_cmp_ne_u32 s[60:61], s51, v178
    v_cmp_ne_u32 s[62:63], s51, v182
    s_or_b64 s[56:57], s[56:57], s[58:59]
    s_or_b64 s[60:61], s[60:61], s[62:63]
    s_and_b64 s[56:57], s[56:57], s[52:53]
    s_and_b64 s[60:61], s[60:61], s[54:55]
    s_or_b64 s[56:57], s[56:57], s[60:61]
    s_cmp_eq_u64 s[56:57], 0
    s_cselect_b32 s7, 1, 0
    v_mov_b32 v250, 4096
    v_mov_b32 v251, s7
    ds_write_b32 v250, v251 offset:4
    s_waitcnt lgkmcnt(0)

L_only_24:
    v_add_u32 v254, 47104, v4
    ds_read_b32 v73, v254 offset:0
    ds_read_b32 v75, v254 offset:896
    ds_read_b32 v77, v254 offset:1792
    ds_read_b32 v79, v254 offset:2688
    ds_read_b32 v81, v254 offset:3584
    ds_read_b32 v83, v254 offset:4480
    ds_read_b32 v85, v254 offset:5376
    ds_read_b32 v87, v254 offset:6272
    s_waitcnt lgkmcnt(0)
    ds_read_b32 v89, v254 offset:7168
    ds_read_b32 v91, v254 offset:8064
    ds_read_b32 v93, v254 offset:8960
    ds_read_b32 v95, v254 offset:9856
    ds_read_b32 v97, v254 offset:10752
    ds_read_b32 v99, v254 offset:11648
    ds_read_b32 v101, v254 offset:12544
    ds_read_b32 v103, v254 offset:13440
    s_waitcnt lgkmcnt(0)
    ds_read_b32 v105, v254 offset:14336
    ds_read_b32 v107, v254 offset:15232
    ds_read_b32 v109, v254 offset:16128
    ds_read_b32 v111, v254 offset:17024
    ds_read_b32 v113, v254 offset:17920
    ds_read_b32 v115, v254 offset:18816
    ds_read_b32 v117, v254 offset:19712
    ds_read_b32 v119, v254 offset:20608
    s_waitcnt lgkmcnt(0)
    ds_read_b32 v121, v254 offset:21504
    ds_read_b32 v123, v254 offset:22400
    ds_read_b32 v125, v254 offset:23296
    ds_read_b32 v127, v254 offset:24192
    ds_read_b32 v129, v254 offset:25088
    ds_read_b32 v131, v254 offset:25984
    ds_read_b32 v133, v254 offset:26880
    ds_read_b32 v135, v254 offset:27776
    s_waitcnt lgkmcnt(0)
    v_lshlrev_b32 v72, 16, v73
    v_and_b32 v73, 0xffff0000, v73
    v_lshlrev_b32 v74, 16, v75
    v_and_b32 v75, 0xffff0000, v75
    v_lshlrev_b32 v76, 16, v77
    v_and_b32 v77, 0xffff0000, v77
    v_lshlrev_b32 v78, 16, v79
    v_and_b32 v79, 0xffff0000, v79
    v_lshlrev_b32 v80, 16, v81
    v_and_b32 v81, 0xffff0000, v81
    v_lshlrev_b32 v82, 16, v83
    v_and_b32 v83, 0xffff0000, v83
    v_lshlrev_b32 v84, 16, v85
    v_and_b32 v85, 0xffff0000, v85
    v_lshlrev_b32 v86, 16, v87
    v_and_b32 v87, 0xffff0000, v87
    v_lshlrev_b32 v88, 16, v89
    v_and_b32 v89, 0xffff0000, v89
    v_lshlrev_b32 v90, 16, v91
    v_and_b32 v91, 0xffff0000, v91
    v_lshlrev_b32 v92, 16, v93
    v_and_b32 v93, 0xffff0000, v93
    v_lshlrev_b32 v94, 16, v95
    v_and_b32 v95, 0xffff0000, v95
    v_lshlrev_b32 v96, 16, v97
    v_and_b32 v97, 0xffff0000, v97
    v_lshlrev_b32 v98, 16, v99
    v_and_b32 v99, 0xffff0000, v99
    v_lshlrev_b32 v100, 16, v101
    v_and_b32 v101, 0xffff0000, v101
    v_lshlrev_b32 v102, 16, v103
    v_and_b32 v103, 0xffff0000, v103
    v_lshlrev_b32 v104, 16, v105
    v_and_b32 v105, 0xffff0000, v105
    v_lshlrev_b32 v106, 16, v107
    v_and_b32 v107, 0xffff0000, v107
    v_lshlrev_b32 v108, 16, v109
    v_and_b32 v109, 0xffff0000, v109
    v_lshlrev_b32 v110, 16, v111
    v_and_b32 v111, 0xffff0000, v111
    v_lshlrev_b32 v112, 16, v113
    v_and_b32 v113, 0xffff0000, v113
    v_lshlrev_b32 v114, 16, v115
    v_and_b32 v115, 0xffff0000, v115
    v_lshlrev_b32 v116, 16, v117
    v_and_b32 v117, 0xffff0000, v117
    v_lshlrev_b32 v118, 16, v119
    v_and_b32 v119, 0xffff0000, v119
    v_lshlrev_b32 v120, 16, v121
    v_and_b32 v121, 0xffff0000, v121
    v_lshlrev_b32 v122, 16, v123
    v_and_b32 v123, 0xffff0000, v123
    v_lshlrev_b32 v124, 16, v125
    v_and_b32 v125, 0xffff0000, v125
    v_lshlrev_b32 v126, 16, v127
    v_and_b32 v127, 0xffff0000, v127
    v_lshlrev_b32 v128, 16, v129
    v_and_b32 v129, 0xffff0000, v129
    v_lshlrev_b32 v130, 16, v131
    v_and_b32 v131, 0xffff0000, v131
    v_lshlrev_b32 v132, 16, v133
    v_and_b32 v133, 0xffff0000, v133
    v_lshlrev_b32 v134, 16, v135
    v_and_b32 v135, 0xffff0000, v135
    s_barrier
    v_mov_b32 v250, 4096
    ds_read_b32 v251, v250 offset:4
    s_waitcnt lgkmcnt(0)
    v_readfirstlane_b32 s7, v251

    s_cmp_ge_u32 s35, 2
    s_cbranch_scc1 L_noa_27

    s_lshl_b32 s28, s4, 16
    s_lshl_b32 s29, s33, 6
    s_add_u32 s28, s28, s29
    s_add_u32 s28, s28, 1048576
    s_add_u32 s29, s28, 32768
    s_lshl_b32 s30, s4, 9
    s_lshr_b32 s31, s33, 4
    s_lshl_b32 s31, s31, 3
    s_add_u32 s30, s30, s31
    s_add_u32 s30, s30, 40960

    s_mov_b32 s34, 0
L_poll_28:
    buffer_load_dwordx2 v[184:185], v9, s[8:11], s30 offen sc1
    buffer_load_dwordx2 v[186:187], v9, s[8:11], s30 offen offset:256 sc1
    buffer_load_dwordx4 v[176:179], v8, s[8:11], s28 offen sc1
    buffer_load_dwordx4 v[180:183], v8, s[8:11], s29 offen sc1
    s_waitcnt vmcnt(0)
    v_max3_u32 v250, v176, v177, v178
    v_max3_u32 v250, v250, v179, v180
    v_max3_u32 v250, v250, v181, v182
    v_max3_u32 v250, v250, v183, v184
    v_max3_u32 v250, v250, v185, v186
    v_max_u32 v250, v250, v187
    v_cmp_eq_u32 vcc, -1, v250
    s_cmp_eq_u64 vcc, 0
    s_cbranch_scc1 L_polld_29

    s_add_u32 s34, s34, 1
    s_cmp_lt_u32 s34, 100000
    s_cbranch_scc1 L_poll_28
L_polld_29:

    v_max_f32 v250, v184, v186
    s_nop 1
    v_max_f32_dpp v250, v250, v250 row_ror:1 row_mask:0xf bank_mask:0xf
    s_nop 1
    v_max_f32_dpp v250, v250, v250 row_ror:2 row_mask:0xf bank_mask:0xf
    s_nop 1
    v_max_f32_dpp v250, v250, v250 row_ror:4 row_mask:0xf bank_mask:0xf
    s_nop 1
    v_max_f32_dpp v250, v250, v250 row_ror:8 row_mask:0xf bank_mask:0xf
    v_sub_f32 v251, v184, v250
    v_sub_f32 v252, v186, v250
    v_exp_f32 v251, v251
    v_exp_f32 v252, v252
    s_nop 0
    v_mul_f32 v253, v251, v185
    v_mul_f32 v176, v251, v176
    v_mul_f32 v177, v251, v177
    v_mul_f32 v178, v251, v178
    v_mul_f32 v179, v251, v179
    v_fmac_f32 v253, v252, v187
    v_fmac_f32 v176, v252, v180
    v_fmac_f32 v177, v252, v181
    v_fmac_f32 v178, v252, v182
    v_fmac_f32 v179, v252, v183

    v_add_f32_dpp v253, v253, v253 row_ror:1 row_mask:0xf bank_mask:0xf
    v_add_f32_dpp v176, v176, v176 row_ror:1 row_mask:0xf bank_mask:0xf
    v_add_f32_dpp v177, v177, v177 row_ror:1 row_mask:0xf bank_mask:0xf
    v_add_f32_dpp v178, v178, v178 row_ror:1 row_mask:0xf bank_mask:0xf
    v_add_f32_dpp v179, v179, v179 row_ror:1 row_mask:0xf bank_mask:0xf
    v_add_f32_dpp v253, v253, v253 row_ror:2 row_mask:0xf bank_mask:0xf
    v_add_f32_dpp v176, v176, v176 row_ror:2 row_mask:0xf bank_mask:0xf
    v_add_f32_dpp v177, v177, v177 row_ror:2 row_mask:0xf bank_mask:0xf
    v_add_f32_dpp v178, v178, v178 row_ror:2 row_mask:0xf bank_mask:0xf
    v_add_f32_dpp v179, v179, v179 row_ror:2 row_mask:0xf bank_mask:0xf
    v_add_f32_dpp v253, v253, v253 row_ror:4 row_mask:0xf bank_mask:0xf
    v_add_f32_dpp v176, v176, v176 row_ror:4 row_mask:0xf bank_mask:0xf
    v_add_f32_dpp v177, v177, v177 row_ror:4 row_mask:0xf bank_mask:0xf
    v_add_f32_dpp v178, v178, v178 row_ror:4 row_mask:0xf bank_mask:0xf
    v_add_f32_dpp v179, v179, v179 row_ror:4 row_mask:0xf bank_mask:0xf
    v_add_f32_dpp v253, v253, v253 row_ror:8 row_mask:0xf bank_mask:0xf
    v_add_f32_dpp v176, v176, v176 row_ror:8 row_mask:0xf bank_mask:0xf
    v_add_f32_dpp v177, v177, v177 row_ror:8 row_mask:0xf bank_mask:0xf
    v_add_f32_dpp v178, v178, v178 row_ror:8 row_mask:0xf bank_mask:0xf
    v_add_f32_dpp v179, v179, v179 row_ror:8 row_mask:0xf bank_mask:0xf
    v_rcp_f32 v253, v253
    s_lshl_b32 s28, s35, 6
    v_lshl_add_u32 v250, v2, 4, s28
    v_mul_f32 v176, v253, v176
    v_mul_f32 v177, v253, v177
    v_mul_f32 v178, v253, v178
    v_mul_f32 v179, v253, v179

    s_mov_b32 exec_lo, 0x00010001
    s_mov_b32 exec_hi, 0x00010001
    ds_write_b128 v250, v[176:179] offset:4160
    s_mov_b64 exec, -1
    s_waitcnt lgkmcnt(0)

L_noa_27:
    s_barrier
    v_mov_b32 v250, 4160
    ds_read_b128 v[176:179], v250 offset:0
    ds_read_b128 v[180:183], v250 offset:16
    ds_read_b128 v[184:187], v250 offset:32
    ds_read_b128 v[188:191], v250 offset:48
    ds_read_b128 v[192:195], v250 offset:64
    ds_read_b128 v[196:199], v250 offset:80
    ds_read_b128 v[200:203], v250 offset:96
    ds_read_b128 v[204:207], v250 offset:112
    s_waitcnt lgkmcnt(7)
    v_pk_mul_f32 v[14:15], v[176:177], v[72:73] op_sel_hi:[0,1]
    v_pk_mul_f32 v[252:253], v[176:177], v[74:75] op_sel:[1,0] op_sel_hi:[1,1]
    v_pk_mul_f32 v[208:209], v[178:179], v[76:77] op_sel_hi:[0,1]
    v_pk_mul_f32 v[210:211], v[178:179], v[78:79] op_sel:[1,0] op_sel_hi:[1,1]
    s_waitcnt lgkmcnt(6)
    v_pk_fma_f32 v[14:15], v[180:181], v[80:81], v[14:15] op_sel_hi:[0,1,1]
    v_pk_fma_f32 v[252:253], v[180:181], v[82:83], v[252:253] op_sel:[1,0,0] op_sel_hi:[1,1,1]
    v_pk_fma_f32 v[208:209], v[182:183], v[84:85], v[208:209] op_sel_hi:[0,1,1]
    v_pk_fma_f32 v[210:211], v[182:183], v[86:87], v[210:211] op_sel:[1,0,0] op_sel_hi:[1,1,1]
    s_waitcnt lgkmcnt(5)
    v_pk_fma_f32 v[14:15], v[184:185], v[88:89], v[14:15] op_sel_hi:[0,1,1]
    v_pk_fma_f32 v[252:253], v[184:185], v[90:91], v[252:253] op_sel:[1,0,0] op_sel_hi:[1,1,1]
    v_pk_fma_f32 v[208:209], v[186:187], v[92:93], v[208:209] op_sel_hi:[0,1,1]
    v_pk_fma_f32 v[210:211], v[186:187], v[94:95], v[210:211] op_sel:[1,0,0] op_sel_hi:[1,1,1]
    s_waitcnt lgkmcnt(4)
    v_pk_fma_f32 v[14:15], v[188:189], v[96:97], v[14:15] op_sel_hi:[0,1,1]
    v_pk_fma_f32 v[252:253], v[188:189], v[98:99], v[252:253] op_sel:[1,0,0] op_sel_hi:[1,1,1]
    v_pk_fma_f32 v[208:209], v[190:191], v[100:101], v[208:209] op_sel_hi:[0,1,1]
    v_pk_fma_f32 v[210:211], v[190:191], v[102:103], v[210:211] op_sel:[1,0,0] op_sel_hi:[1,1,1]
    s_waitcnt lgkmcnt(3)
    v_pk_fma_f32 v[14:15], v[192:193], v[104:105], v[14:15] op_sel_hi:[0,1,1]
    v_pk_fma_f32 v[252:253], v[192:193], v[106:107], v[252:253] op_sel:[1,0,0] op_sel_hi:[1,1,1]
    v_pk_fma_f32 v[208:209], v[194:195], v[108:109], v[208:209] op_sel_hi:[0,1,1]
    v_pk_fma_f32 v[210:211], v[194:195], v[110:111], v[210:211] op_sel:[1,0,0] op_sel_hi:[1,1,1]
    s_waitcnt lgkmcnt(2)
    v_pk_fma_f32 v[14:15], v[196:197], v[112:113], v[14:15] op_sel_hi:[0,1,1]
    v_pk_fma_f32 v[252:253], v[196:197], v[114:115], v[252:253] op_sel:[1,0,0] op_sel_hi:[1,1,1]
    v_pk_fma_f32 v[208:209], v[198:199], v[116:117], v[208:209] op_sel_hi:[0,1,1]
    v_pk_fma_f32 v[210:211], v[198:199], v[118:119], v[210:211] op_sel:[1,0,0] op_sel_hi:[1,1,1]
    s_waitcnt lgkmcnt(1)
    v_pk_fma_f32 v[14:15], v[200:201], v[120:121], v[14:15] op_sel_hi:[0,1,1]
    v_pk_fma_f32 v[252:253], v[200:201], v[122:123], v[252:253] op_sel:[1,0,0] op_sel_hi:[1,1,1]
    v_pk_fma_f32 v[208:209], v[202:203], v[124:125], v[208:209] op_sel_hi:[0,1,1]
    v_pk_fma_f32 v[210:211], v[202:203], v[126:127], v[210:211] op_sel:[1,0,0] op_sel_hi:[1,1,1]
    s_waitcnt lgkmcnt(0)
    v_pk_fma_f32 v[14:15], v[204:205], v[128:129], v[14:15] op_sel_hi:[0,1,1]
    v_pk_fma_f32 v[252:253], v[204:205], v[130:131], v[252:253] op_sel:[1,0,0] op_sel_hi:[1,1,1]
    v_pk_fma_f32 v[208:209], v[206:207], v[132:133], v[208:209] op_sel_hi:[0,1,1]
    v_pk_fma_f32 v[210:211], v[206:207], v[134:135], v[210:211] op_sel:[1,0,0] op_sel_hi:[1,1,1]
    v_pk_add_f32 v[14:15], v[14:15], v[252:253]
    v_pk_add_f32 v[208:209], v[208:209], v[210:211]
    v_pk_add_f32 v[14:15], v[14:15], v[208:209]

    s_lshl_b32 s28, s4, 16
    s_lshl_b32 s29, s5, 11
    s_add_u32 s28, s28, s29
    s_add_u32 s28, s28, 2097152
    s_mov_b64 exec, s[36:37]

    s_cmp_eq_u32 s7, 0
    s_cbranch_scc1 L_slow_30
    buffer_store_dwordx2 v[14:15], v3, s[8:11], s28 offen
    s_branch L_pubd_31
L_slow_30:
    buffer_store_dwordx2 v[14:15], v3, s[8:11], s28 offen sc1
L_pubd_31:

    s_mov_b64 exec, -1
    s_barrier
    s_barrier
    s_cmp_lg_u32 s35, 2
    s_cbranch_scc1 L_only_32

    s_cmp_ge_u32 s5, 14
    s_cbranch_scc1 L_nored_33
    s_lshl_b32 s28, s4, 16
    s_lshl_b32 s29, s5, 7
    s_add_u32 s28, s28, s29
    s_add_u32 s28, s28, 2097152
    s_add_u32 s29, s28, 16384
    s_add_u32 s30, s28, 32768
    s_add_u32 s31, s28, 49152

    s_mov_b32 s34, 0
L_poll_34:
    buffer_load_dwordx4 v[176:179], v12, s[8:11], s28 offen sc1
    buffer_load_dwordx4 v[180:183], v12, s[8:11], s29 offen sc1
    s_waitcnt vmcnt(0)
    v_max3_u32 v250, v176, v177, v178
    v_max3_u32 v250, v250, v179, v180
    v_max3_u32 v250, v250, v181, v182
    v_max_u32 v250, v250, v183
    v_cmp_eq_u32 vcc, -1, v250
    s_cmp_eq_u64 vcc, 0
    s_cbranch_scc1 L_polld_35

    s_add_u32 s34, s34, 1
    s_cmp_lt_u32 s34, 100000
    s_cbranch_scc1 L_poll_34
L_polld_35:

    v_add_f32 v176, v176, v180
    v_add_f32 v177, v177, v181
    v_add_f32 v178, v178, v182
    v_add_f32 v179, v179, v183
    s_nop 0
    v_add_f32_dpp v176, v176, v176 row_ror:2 row_mask:0xf bank_mask:0xf
    v_add_f32_dpp v177, v177, v177 row_ror:2 row_mask:0xf bank_mask:0xf
    v_add_f32_dpp v178, v178, v178 row_ror:2 row_mask:0xf bank_mask:0xf
    v_add_f32_dpp v179, v179, v179 row_ror:2 row_mask:0xf bank_mask:0xf
    v_add_f32_dpp v176, v176, v176 row_ror:4 row_mask:0xf bank_mask:0xf
    v_add_f32_dpp v177, v177, v177 row_ror:4 row_mask:0xf bank_mask:0xf
    v_add_f32_dpp v178, v178, v178 row_ror:4 row_mask:0xf bank_mask:0xf
    v_add_f32_dpp v179, v179, v179 row_ror:4 row_mask:0xf bank_mask:0xf
    v_add_f32_dpp v176, v176, v176 row_ror:8 row_mask:0xf bank_mask:0xf
    v_add_f32_dpp v177, v177, v177 row_ror:8 row_mask:0xf bank_mask:0xf
    v_add_f32_dpp v178, v178, v178 row_ror:8 row_mask:0xf bank_mask:0xf
    v_add_f32_dpp v179, v179, v179 row_ror:8 row_mask:0xf bank_mask:0xf
    s_lshl_b32 s28, s4, 7
    s_lshl_b32 s29, s5, 10
    s_add_u32 s28, s28, s29
    s_add_u32 s28, s28, 262144
    buffer_store_dwordx4 v[176:179], v10, s[8:11], s28 offen sc1
    s_lshl_b32 s28, s4, 14
    s_add_u32 s28, s28, s29
    s_add_u32 s28, s28, 262144

    s_mov_b32 s34, 0
L_poll_36:
    buffer_load_dwordx4 v[192:195], v11, s[8:11], s28 offen sc1
    s_waitcnt vmcnt(0)
    v_max3_u32 v250, v192, v193, v194
    v_max_u32 v250, v250, v195
    v_cmp_eq_u32 vcc, -1, v250
    s_cmp_eq_u64 vcc, 0
    s_cbranch_scc1 L_polld_37

    s_add_u32 s34, s34, 1
    s_cmp_lt_u32 s34, 100000
    s_cbranch_scc1 L_poll_36
L_polld_37:

    v_add_f32_dpp v192, v192, v192 row_ror:2 row_mask:0xf bank_mask:0xf
    v_add_f32_dpp v193, v193, v193 row_ror:2 row_mask:0xf bank_mask:0xf
    v_add_f32_dpp v194, v194, v194 row_ror:2 row_mask:0xf bank_mask:0xf
    v_add_f32_dpp v195, v195, v195 row_ror:2 row_mask:0xf bank_mask:0xf
    v_add_f32_dpp v192, v192, v192 row_ror:4 row_mask:0xf bank_mask:0xf
    v_add_f32_dpp v193, v193, v193 row_ror:4 row_mask:0xf bank_mask:0xf
    v_add_f32_dpp v194, v194, v194 row_ror:4 row_mask:0xf bank_mask:0xf
    v_add_f32_dpp v195, v195, v195 row_ror:4 row_mask:0xf bank_mask:0xf
    v_add_f32_dpp v192, v192, v192 row_ror:8 row_mask:0xf bank_mask:0xf
    v_add_f32_dpp v193, v193, v193 row_ror:8 row_mask:0xf bank_mask:0xf
    v_add_f32_dpp v194, v194, v194 row_ror:8 row_mask:0xf bank_mask:0xf
    v_add_f32_dpp v195, v195, v195 row_ror:8 row_mask:0xf bank_mask:0xf
    v_pk_add_f32 v[16:17], v[16:17], v[192:193]
    v_pk_add_f32 v[18:19], v[18:19], v[194:195]
    v_cvt_pk_bf16_f32 v14, v16, v17
    v_cvt_pk_bf16_f32 v15, v18, v19
    v_lshrrev_b32 v250, 1, v13
    s_mov_b32 exec_lo, 0x00030003
    s_mov_b32 exec_hi, 0x00030003

    s_lshl_b32 s28, s4, 10
    s_lshl_b32 s29, s5, 6
    s_add_u32 s28, s28, s29
    s_add_u32 s28, s28, 131072

    s_cmp_eq_u32 s7, 0
    s_cbranch_scc1 L_slow_38
    buffer_store_dwordx2 v[14:15], v250, s[8:11], s28 offen
    s_branch L_pubd_39
L_slow_38:
    buffer_store_dwordx2 v[14:15], v250, s[8:11], s28 offen sc1
L_pubd_39:

    s_mov_b64 exec, -1
    v_lshlrev_b32 v16, 16, v14
    v_and_b32 v17, 0xffff0000, v14
    v_lshlrev_b32 v18, 16, v15
    v_and_b32 v19, 0xffff0000, v15

L_nored_33:
    s_cmp_ge_u32 s5, 14
    s_cbranch_scc1 L_nored_40
    s_lshl_b32 s28, s4, 16
    s_lshl_b32 s29, s5, 7
    s_add_u32 s28, s28, s29
    s_add_u32 s28, s28, 2621440
    s_add_u32 s29, s28, 16384
    s_add_u32 s30, s28, 32768
    s_add_u32 s31, s28, 49152

    v_mov_b32 v188, 0
    v_mov_b32 v189, 0
    v_mov_b32 v190, 0
    v_mov_b32 v191, 0
    s_mov_b32 s34, 0
L_poll_41:
    buffer_load_dwordx4 v[176:179], v12, s[8:11], s28 offen sc1
    buffer_load_dwordx4 v[180:183], v12, s[8:11], s29 offen sc1
    buffer_load_dwordx4 v[184:187], v12, s[8:11], s30 offen sc1
    s_mov_b32 exec_lo, 0x00ff00ff
    s_mov_b32 exec_hi, 0x00ff00ff
    buffer_load_dwordx4 v[188:191], v12, s[8:11], s31 offen sc1
    s_mov_b64 exec, -1
    s_waitcnt vmcnt(0)
    v_max3_u32 v250, v176, v177, v178
    v_max3_u32 v250, v250, v179, v180
    v_max3_u32 v250, v250, v181, v182
    v_max3_u32 v250, v250, v183, v184
    v_max3_u32 v250, v250, v185, v186
    v_max3_u32 v250, v250, v187, v188
    v_max3_u32 v250, v250, v189, v190
    v_max_u32 v250, v250, v191
    v_cmp_eq_u32 vcc, -1, v250
    s_cmp_eq_u64 vcc, 0
    s_cbranch_scc1 L_polld_42

    s_add_u32 s34, s34, 1
    s_cmp_lt_u32 s34, 100000
    s_cbranch_scc1 L_poll_41
L_polld_42:

    v_add_f32 v176, v176, v180
    v_add_f32 v184, v184, v188
    v_add_f32 v177, v177, v181
    v_add_f32 v185, v185, v189
    v_add_f32 v178, v178, v182
    v_add_f32 v186, v186, v190
    v_add_f32 v179, v179, v183
    v_add_f32 v187, v187, v191
    v_add_f32 v176, v176, v184
    v_add_f32 v177, v177, v185
    v_add_f32 v178, v178, v186
    v_add_f32 v179, v179, v187
    s_nop 0
    v_add_f32_dpp v176, v176, v176 row_ror:2 row_mask:0xf bank_mask:0xf
    v_add_f32_dpp v177, v177, v177 row_ror:2 row_mask:0xf bank_mask:0xf
    v_add_f32_dpp v178, v178, v178 row_ror:2 row_mask:0xf bank_mask:0xf
    v_add_f32_dpp v179, v179, v179 row_ror:2 row_mask:0xf bank_mask:0xf
    v_add_f32_dpp v176, v176, v176 row_ror:4 row_mask:0xf bank_mask:0xf
    v_add_f32_dpp v177, v177, v177 row_ror:4 row_mask:0xf bank_mask:0xf
    v_add_f32_dpp v178, v178, v178 row_ror:4 row_mask:0xf bank_mask:0xf
    v_add_f32_dpp v179, v179, v179 row_ror:4 row_mask:0xf bank_mask:0xf
    v_add_f32_dpp v176, v176, v176 row_ror:8 row_mask:0xf bank_mask:0xf
    v_add_f32_dpp v177, v177, v177 row_ror:8 row_mask:0xf bank_mask:0xf
    v_add_f32_dpp v178, v178, v178 row_ror:8 row_mask:0xf bank_mask:0xf
    v_add_f32_dpp v179, v179, v179 row_ror:8 row_mask:0xf bank_mask:0xf
    s_lshl_b32 s28, s4, 7
    s_lshl_b32 s29, s5, 10
    s_add_u32 s28, s28, s29
    s_add_u32 s28, s28, 393216
    buffer_store_dwordx4 v[176:179], v10, s[8:11], s28 offen sc1
    s_lshl_b32 s28, s4, 14
    s_add_u32 s28, s28, s29
    s_add_u32 s28, s28, 393216

    s_mov_b32 s34, 0
L_poll_43:
    buffer_load_dwordx4 v[192:195], v11, s[8:11], s28 offen sc1
    s_waitcnt vmcnt(0)
    v_max3_u32 v250, v192, v193, v194
    v_max_u32 v250, v250, v195
    v_cmp_eq_u32 vcc, -1, v250
    s_cmp_eq_u64 vcc, 0
    s_cbranch_scc1 L_polld_44

    s_add_u32 s34, s34, 1
    s_cmp_lt_u32 s34, 100000
    s_cbranch_scc1 L_poll_43
L_polld_44:

    v_add_f32_dpp v192, v192, v192 row_ror:2 row_mask:0xf bank_mask:0xf
    v_add_f32_dpp v193, v193, v193 row_ror:2 row_mask:0xf bank_mask:0xf
    v_add_f32_dpp v194, v194, v194 row_ror:2 row_mask:0xf bank_mask:0xf
    v_add_f32_dpp v195, v195, v195 row_ror:2 row_mask:0xf bank_mask:0xf
    v_add_f32_dpp v192, v192, v192 row_ror:4 row_mask:0xf bank_mask:0xf
    v_add_f32_dpp v193, v193, v193 row_ror:4 row_mask:0xf bank_mask:0xf
    v_add_f32_dpp v194, v194, v194 row_ror:4 row_mask:0xf bank_mask:0xf
    v_add_f32_dpp v195, v195, v195 row_ror:4 row_mask:0xf bank_mask:0xf
    v_add_f32_dpp v192, v192, v192 row_ror:8 row_mask:0xf bank_mask:0xf
    v_add_f32_dpp v193, v193, v193 row_ror:8 row_mask:0xf bank_mask:0xf
    v_add_f32_dpp v194, v194, v194 row_ror:8 row_mask:0xf bank_mask:0xf
    v_add_f32_dpp v195, v195, v195 row_ror:8 row_mask:0xf bank_mask:0xf
    v_pk_add_f32 v[16:17], v[16:17], v[192:193]
    v_pk_add_f32 v[18:19], v[18:19], v[194:195]
    v_cvt_pk_bf16_f32 v14, v16, v17
    v_cvt_pk_bf16_f32 v15, v18, v19
    v_lshrrev_b32 v250, 1, v13
    s_mov_b32 exec_lo, 0x00030003
    s_mov_b32 exec_hi, 0x00030003

    s_lshl_b32 s28, s4, 10
    s_lshl_b32 s29, s5, 6
    s_add_u32 s28, s28, s29
    s_add_u32 s28, s28, 139264

    s_cmp_eq_u32 s7, 0
    s_cbranch_scc1 L_slow_45
    buffer_store_dwordx2 v[14:15], v250, s[8:11], s28 offen
    s_branch L_pubd_46
L_slow_45:
    buffer_store_dwordx2 v[14:15], v250, s[8:11], s28 offen sc1
L_pubd_46:

    s_mov_b64 exec, -1
    v_lshlrev_b32 v16, 16, v14
    v_and_b32 v17, 0xffff0000, v14
    v_lshlrev_b32 v18, 16, v15
    v_and_b32 v19, 0xffff0000, v15

L_nored_40:
L_only_32:
    s_barrier
    s_barrier
    s_cmp_ge_u32 s35, 2
    s_cbranch_scc1 L_noa_47

    s_lshl_b32 s28, s4, 16
    s_lshl_b32 s29, s33, 6
    s_add_u32 s28, s28, s29
    s_add_u32 s28, s28, 1572864
    s_add_u32 s29, s28, 32768
    s_lshl_b32 s30, s4, 9
    s_lshr_b32 s31, s33, 4
    s_lshl_b32 s31, s31, 3
    s_add_u32 s30, s30, s31
    s_add_u32 s30, s30, 45056

    s_mov_b32 s34, 0
L_poll_48:
    buffer_load_dwordx2 v[184:185], v9, s[8:11], s30 offen sc1
    buffer_load_dwordx2 v[186:187], v9, s[8:11], s30 offen offset:256 sc1
    buffer_load_dwordx4 v[176:179], v8, s[8:11], s28 offen sc1
    buffer_load_dwordx4 v[180:183], v8, s[8:11], s29 offen sc1
    s_waitcnt vmcnt(0)
    v_max3_u32 v250, v176, v177, v178
    v_max3_u32 v250, v250, v179, v180
    v_max3_u32 v250, v250, v181, v182
    v_max3_u32 v250, v250, v183, v184
    v_max3_u32 v250, v250, v185, v186
    v_max_u32 v250, v250, v187
    v_cmp_eq_u32 vcc, -1, v250
    s_cmp_eq_u64 vcc, 0
    s_cbranch_scc1 L_polld_49

    s_add_u32 s34, s34, 1
    s_cmp_lt_u32 s34, 100000
    s_cbranch_scc1 L_poll_48
L_polld_49:

    v_max_f32 v250, v184, v186
    s_nop 1
    v_max_f32_dpp v250, v250, v250 row_ror:1 row_mask:0xf bank_mask:0xf
    s_nop 1
    v_max_f32_dpp v250, v250, v250 row_ror:2 row_mask:0xf bank_mask:0xf
    s_nop 1
    v_max_f32_dpp v250, v250, v250 row_ror:4 row_mask:0xf bank_mask:0xf
    s_nop 1
    v_max_f32_dpp v250, v250, v250 row_ror:8 row_mask:0xf bank_mask:0xf
    v_sub_f32 v251, v184, v250
    v_sub_f32 v252, v186, v250
    v_exp_f32 v251, v251
    v_exp_f32 v252, v252
    s_nop 0
    v_mul_f32 v253, v251, v185
    v_mul_f32 v176, v251, v176
    v_mul_f32 v177, v251, v177
    v_mul_f32 v178, v251, v178
    v_mul_f32 v179, v251, v179
    v_fmac_f32 v253, v252, v187
    v_fmac_f32 v176, v252, v180
    v_fmac_f32 v177, v252, v181
    v_fmac_f32 v178, v252, v182
    v_fmac_f32 v179, v252, v183

    v_add_f32_dpp v253, v253, v253 row_ror:1 row_mask:0xf bank_mask:0xf
    v_add_f32_dpp v176, v176, v176 row_ror:1 row_mask:0xf bank_mask:0xf
    v_add_f32_dpp v177, v177, v177 row_ror:1 row_mask:0xf bank_mask:0xf
    v_add_f32_dpp v178, v178, v178 row_ror:1 row_mask:0xf bank_mask:0xf
    v_add_f32_dpp v179, v179, v179 row_ror:1 row_mask:0xf bank_mask:0xf
    v_add_f32_dpp v253, v253, v253 row_ror:2 row_mask:0xf bank_mask:0xf
    v_add_f32_dpp v176, v176, v176 row_ror:2 row_mask:0xf bank_mask:0xf
    v_add_f32_dpp v177, v177, v177 row_ror:2 row_mask:0xf bank_mask:0xf
    v_add_f32_dpp v178, v178, v178 row_ror:2 row_mask:0xf bank_mask:0xf
    v_add_f32_dpp v179, v179, v179 row_ror:2 row_mask:0xf bank_mask:0xf
    v_add_f32_dpp v253, v253, v253 row_ror:4 row_mask:0xf bank_mask:0xf
    v_add_f32_dpp v176, v176, v176 row_ror:4 row_mask:0xf bank_mask:0xf
    v_add_f32_dpp v177, v177, v177 row_ror:4 row_mask:0xf bank_mask:0xf
    v_add_f32_dpp v178, v178, v178 row_ror:4 row_mask:0xf bank_mask:0xf
    v_add_f32_dpp v179, v179, v179 row_ror:4 row_mask:0xf bank_mask:0xf
    v_add_f32_dpp v253, v253, v253 row_ror:8 row_mask:0xf bank_mask:0xf
    v_add_f32_dpp v176, v176, v176 row_ror:8 row_mask:0xf bank_mask:0xf
    v_add_f32_dpp v177, v177, v177 row_ror:8 row_mask:0xf bank_mask:0xf
    v_add_f32_dpp v178, v178, v178 row_ror:8 row_mask:0xf bank_mask:0xf
    v_add_f32_dpp v179, v179, v179 row_ror:8 row_mask:0xf bank_mask:0xf
    v_rcp_f32 v253, v253
    s_lshl_b32 s28, s35, 6
    v_lshl_add_u32 v250, v2, 4, s28
    v_mul_f32 v176, v253, v176
    v_mul_f32 v177, v253, v177
    v_mul_f32 v178, v253, v178
    v_mul_f32 v179, v253, v179

    s_mov_b32 exec_lo, 0x00010001
    s_mov_b32 exec_hi, 0x00010001
    ds_write_b128 v250, v[176:179] offset:4160
    s_mov_b64 exec, -1
    s_waitcnt lgkmcnt(0)

L_noa_47:
    s_barrier
    v_mov_b32 v250, 4160
    ds_read_b128 v[176:179], v250 offset:0
    ds_read_b128 v[180:183], v250 offset:16
    ds_read_b128 v[184:187], v250 offset:32
    ds_read_b128 v[188:191], v250 offset:48
    ds_read_b128 v[192:195], v250 offset:64
    ds_read_b128 v[196:199], v250 offset:80
    ds_read_b128 v[200:203], v250 offset:96
    ds_read_b128 v[204:207], v250 offset:112
    s_waitcnt lgkmcnt(7)
    v_pk_mul_f32 v[14:15], v[176:177], v[72:73] op_sel_hi:[0,1]
    v_pk_mul_f32 v[252:253], v[176:177], v[74:75] op_sel:[1,0] op_sel_hi:[1,1]
    v_pk_mul_f32 v[208:209], v[178:179], v[76:77] op_sel_hi:[0,1]
    v_pk_mul_f32 v[210:211], v[178:179], v[78:79] op_sel:[1,0] op_sel_hi:[1,1]
    s_waitcnt lgkmcnt(6)
    v_pk_fma_f32 v[14:15], v[180:181], v[80:81], v[14:15] op_sel_hi:[0,1,1]
    v_pk_fma_f32 v[252:253], v[180:181], v[82:83], v[252:253] op_sel:[1,0,0] op_sel_hi:[1,1,1]
    v_pk_fma_f32 v[208:209], v[182:183], v[84:85], v[208:209] op_sel_hi:[0,1,1]
    v_pk_fma_f32 v[210:211], v[182:183], v[86:87], v[210:211] op_sel:[1,0,0] op_sel_hi:[1,1,1]
    s_waitcnt lgkmcnt(5)
    v_pk_fma_f32 v[14:15], v[184:185], v[88:89], v[14:15] op_sel_hi:[0,1,1]
    v_pk_fma_f32 v[252:253], v[184:185], v[90:91], v[252:253] op_sel:[1,0,0] op_sel_hi:[1,1,1]
    v_pk_fma_f32 v[208:209], v[186:187], v[92:93], v[208:209] op_sel_hi:[0,1,1]
    v_pk_fma_f32 v[210:211], v[186:187], v[94:95], v[210:211] op_sel:[1,0,0] op_sel_hi:[1,1,1]
    s_waitcnt lgkmcnt(4)
    v_pk_fma_f32 v[14:15], v[188:189], v[96:97], v[14:15] op_sel_hi:[0,1,1]
    v_pk_fma_f32 v[252:253], v[188:189], v[98:99], v[252:253] op_sel:[1,0,0] op_sel_hi:[1,1,1]
    v_pk_fma_f32 v[208:209], v[190:191], v[100:101], v[208:209] op_sel_hi:[0,1,1]
    v_pk_fma_f32 v[210:211], v[190:191], v[102:103], v[210:211] op_sel:[1,0,0] op_sel_hi:[1,1,1]
    s_waitcnt lgkmcnt(3)
    v_pk_fma_f32 v[14:15], v[192:193], v[104:105], v[14:15] op_sel_hi:[0,1,1]
    v_pk_fma_f32 v[252:253], v[192:193], v[106:107], v[252:253] op_sel:[1,0,0] op_sel_hi:[1,1,1]
    v_pk_fma_f32 v[208:209], v[194:195], v[108:109], v[208:209] op_sel_hi:[0,1,1]
    v_pk_fma_f32 v[210:211], v[194:195], v[110:111], v[210:211] op_sel:[1,0,0] op_sel_hi:[1,1,1]
    s_waitcnt lgkmcnt(2)
    v_pk_fma_f32 v[14:15], v[196:197], v[112:113], v[14:15] op_sel_hi:[0,1,1]
    v_pk_fma_f32 v[252:253], v[196:197], v[114:115], v[252:253] op_sel:[1,0,0] op_sel_hi:[1,1,1]
    v_pk_fma_f32 v[208:209], v[198:199], v[116:117], v[208:209] op_sel_hi:[0,1,1]
    v_pk_fma_f32 v[210:211], v[198:199], v[118:119], v[210:211] op_sel:[1,0,0] op_sel_hi:[1,1,1]
    s_waitcnt lgkmcnt(1)
    v_pk_fma_f32 v[14:15], v[200:201], v[120:121], v[14:15] op_sel_hi:[0,1,1]
    v_pk_fma_f32 v[252:253], v[200:201], v[122:123], v[252:253] op_sel:[1,0,0] op_sel_hi:[1,1,1]
    v_pk_fma_f32 v[208:209], v[202:203], v[124:125], v[208:209] op_sel_hi:[0,1,1]
    v_pk_fma_f32 v[210:211], v[202:203], v[126:127], v[210:211] op_sel:[1,0,0] op_sel_hi:[1,1,1]
    s_waitcnt lgkmcnt(0)
    v_pk_fma_f32 v[14:15], v[204:205], v[128:129], v[14:15] op_sel_hi:[0,1,1]
    v_pk_fma_f32 v[252:253], v[204:205], v[130:131], v[252:253] op_sel:[1,0,0] op_sel_hi:[1,1,1]
    v_pk_fma_f32 v[208:209], v[206:207], v[132:133], v[208:209] op_sel_hi:[0,1,1]
    v_pk_fma_f32 v[210:211], v[206:207], v[134:135], v[210:211] op_sel:[1,0,0] op_sel_hi:[1,1,1]
    v_pk_add_f32 v[14:15], v[14:15], v[252:253]
    v_pk_add_f32 v[208:209], v[208:209], v[210:211]
    v_pk_add_f32 v[14:15], v[14:15], v[208:209]

    s_lshl_b32 s28, s4, 16
    s_lshl_b32 s29, s5, 11
    s_add_u32 s28, s28, s29
    s_add_u32 s28, s28, 3145728
    s_mov_b64 exec, s[36:37]

    s_cmp_eq_u32 s7, 0
    s_cbranch_scc1 L_slow_50
    buffer_store_dwordx2 v[14:15], v3, s[8:11], s28 offen
    s_branch L_pubd_51
L_slow_50:
    buffer_store_dwordx2 v[14:15], v3, s[8:11], s28 offen sc1
L_pubd_51:

    s_mov_b64 exec, -1
    s_cmp_lg_u32 s35, 2
    s_cbranch_scc1 L_only_52

    s_cmp_ge_u32 s5, 14
    s_cbranch_scc1 L_nored_53
    s_lshl_b32 s28, s4, 16
    s_lshl_b32 s29, s5, 7
    s_add_u32 s28, s28, s29
    s_add_u32 s28, s28, 3145728
    s_add_u32 s29, s28, 16384
    s_add_u32 s30, s28, 32768
    s_add_u32 s31, s28, 49152

    s_mov_b32 s34, 0
L_poll_54:
    buffer_load_dwordx4 v[176:179], v12, s[8:11], s28 offen sc1
    buffer_load_dwordx4 v[180:183], v12, s[8:11], s29 offen sc1
    s_waitcnt vmcnt(0)
    v_max3_u32 v250, v176, v177, v178
    v_max3_u32 v250, v250, v179, v180
    v_max3_u32 v250, v250, v181, v182
    v_max_u32 v250, v250, v183
    v_cmp_eq_u32 vcc, -1, v250
    s_cmp_eq_u64 vcc, 0
    s_cbranch_scc1 L_polld_55

    s_add_u32 s34, s34, 1
    s_cmp_lt_u32 s34, 100000
    s_cbranch_scc1 L_poll_54
L_polld_55:

    v_add_f32 v176, v176, v180
    v_add_f32 v177, v177, v181
    v_add_f32 v178, v178, v182
    v_add_f32 v179, v179, v183
    s_nop 0
    v_add_f32_dpp v176, v176, v176 row_ror:2 row_mask:0xf bank_mask:0xf
    v_add_f32_dpp v177, v177, v177 row_ror:2 row_mask:0xf bank_mask:0xf
    v_add_f32_dpp v178, v178, v178 row_ror:2 row_mask:0xf bank_mask:0xf
    v_add_f32_dpp v179, v179, v179 row_ror:2 row_mask:0xf bank_mask:0xf
    v_add_f32_dpp v176, v176, v176 row_ror:4 row_mask:0xf bank_mask:0xf
    v_add_f32_dpp v177, v177, v177 row_ror:4 row_mask:0xf bank_mask:0xf
    v_add_f32_dpp v178, v178, v178 row_ror:4 row_mask:0xf bank_mask:0xf
    v_add_f32_dpp v179, v179, v179 row_ror:4 row_mask:0xf bank_mask:0xf
    v_add_f32_dpp v176, v176, v176 row_ror:8 row_mask:0xf bank_mask:0xf
    v_add_f32_dpp v177, v177, v177 row_ror:8 row_mask:0xf bank_mask:0xf
    v_add_f32_dpp v178, v178, v178 row_ror:8 row_mask:0xf bank_mask:0xf
    v_add_f32_dpp v179, v179, v179 row_ror:8 row_mask:0xf bank_mask:0xf
    s_lshl_b32 s28, s4, 7
    s_lshl_b32 s29, s5, 10
    s_add_u32 s28, s28, s29
    s_add_u32 s28, s28, 524288
    buffer_store_dwordx4 v[176:179], v10, s[8:11], s28 offen sc1
    s_lshl_b32 s28, s4, 14
    s_add_u32 s28, s28, s29
    s_add_u32 s28, s28, 524288

    s_mov_b32 s34, 0
L_poll_56:
    buffer_load_dwordx4 v[192:195], v11, s[8:11], s28 offen sc1
    s_waitcnt vmcnt(0)
    v_max3_u32 v250, v192, v193, v194
    v_max_u32 v250, v250, v195
    v_cmp_eq_u32 vcc, -1, v250
    s_cmp_eq_u64 vcc, 0
    s_cbranch_scc1 L_polld_57

    s_add_u32 s34, s34, 1
    s_cmp_lt_u32 s34, 100000
    s_cbranch_scc1 L_poll_56
L_polld_57:

    v_add_f32_dpp v192, v192, v192 row_ror:2 row_mask:0xf bank_mask:0xf
    v_add_f32_dpp v193, v193, v193 row_ror:2 row_mask:0xf bank_mask:0xf
    v_add_f32_dpp v194, v194, v194 row_ror:2 row_mask:0xf bank_mask:0xf
    v_add_f32_dpp v195, v195, v195 row_ror:2 row_mask:0xf bank_mask:0xf
    v_add_f32_dpp v192, v192, v192 row_ror:4 row_mask:0xf bank_mask:0xf
    v_add_f32_dpp v193, v193, v193 row_ror:4 row_mask:0xf bank_mask:0xf
    v_add_f32_dpp v194, v194, v194 row_ror:4 row_mask:0xf bank_mask:0xf
    v_add_f32_dpp v195, v195, v195 row_ror:4 row_mask:0xf bank_mask:0xf
    v_add_f32_dpp v192, v192, v192 row_ror:8 row_mask:0xf bank_mask:0xf
    v_add_f32_dpp v193, v193, v193 row_ror:8 row_mask:0xf bank_mask:0xf
    v_add_f32_dpp v194, v194, v194 row_ror:8 row_mask:0xf bank_mask:0xf
    v_add_f32_dpp v195, v195, v195 row_ror:8 row_mask:0xf bank_mask:0xf
    v_pk_add_f32 v[16:17], v[16:17], v[192:193]
    v_pk_add_f32 v[18:19], v[18:19], v[194:195]
    v_cvt_pk_bf16_f32 v14, v16, v17
    v_cvt_pk_bf16_f32 v15, v18, v19
    v_lshrrev_b32 v250, 1, v13
    s_mov_b32 exec_lo, 0x00030003
    s_mov_b32 exec_hi, 0x00030003

    s_lshl_b32 s28, s4, 10
    s_lshl_b32 s29, s5, 6
    s_add_u32 s28, s28, s29
    s_add_u32 s28, s28, 147456

    s_cmp_eq_u32 s7, 0
    s_cbranch_scc1 L_slow_58
    buffer_store_dwordx2 v[14:15], v250, s[8:11], s28 offen
    s_branch L_pubd_59
L_slow_58:
    buffer_store_dwordx2 v[14:15], v250, s[8:11], s28 offen sc1
L_pubd_59:

    s_mov_b64 exec, -1
    v_lshlrev_b32 v16, 16, v14
    v_and_b32 v17, 0xffff0000, v14
    v_lshlrev_b32 v18, 16, v15
    v_and_b32 v19, 0xffff0000, v15

L_nored_53:
    s_cmp_ge_u32 s5, 14
    s_cbranch_scc1 L_nored_60
    s_lshl_b32 s28, s4, 16
    s_lshl_b32 s29, s5, 7
    s_add_u32 s28, s28, s29
    s_add_u32 s28, s28, 3670016
    s_add_u32 s29, s28, 16384
    s_add_u32 s30, s28, 32768
    s_add_u32 s31, s28, 49152

    v_mov_b32 v188, 0
    v_mov_b32 v189, 0
    v_mov_b32 v190, 0
    v_mov_b32 v191, 0
    s_mov_b32 s34, 0
L_poll_61:
    buffer_load_dwordx4 v[176:179], v12, s[8:11], s28 offen sc1
    buffer_load_dwordx4 v[180:183], v12, s[8:11], s29 offen sc1
    buffer_load_dwordx4 v[184:187], v12, s[8:11], s30 offen sc1
    s_mov_b32 exec_lo, 0x00ff00ff
    s_mov_b32 exec_hi, 0x00ff00ff
    buffer_load_dwordx4 v[188:191], v12, s[8:11], s31 offen sc1
    s_mov_b64 exec, -1
    s_waitcnt vmcnt(0)
    v_max3_u32 v250, v176, v177, v178
    v_max3_u32 v250, v250, v179, v180
    v_max3_u32 v250, v250, v181, v182
    v_max3_u32 v250, v250, v183, v184
    v_max3_u32 v250, v250, v185, v186
    v_max3_u32 v250, v250, v187, v188
    v_max3_u32 v250, v250, v189, v190
    v_max_u32 v250, v250, v191
    v_cmp_eq_u32 vcc, -1, v250
    s_cmp_eq_u64 vcc, 0
    s_cbranch_scc1 L_polld_62

    s_add_u32 s34, s34, 1
    s_cmp_lt_u32 s34, 100000
    s_cbranch_scc1 L_poll_61
L_polld_62:

    v_add_f32 v176, v176, v180
    v_add_f32 v184, v184, v188
    v_add_f32 v177, v177, v181
    v_add_f32 v185, v185, v189
    v_add_f32 v178, v178, v182
    v_add_f32 v186, v186, v190
    v_add_f32 v179, v179, v183
    v_add_f32 v187, v187, v191
    v_add_f32 v176, v176, v184
    v_add_f32 v177, v177, v185
    v_add_f32 v178, v178, v186
    v_add_f32 v179, v179, v187
    s_nop 0
    v_add_f32_dpp v176, v176, v176 row_ror:2 row_mask:0xf bank_mask:0xf
    v_add_f32_dpp v177, v177, v177 row_ror:2 row_mask:0xf bank_mask:0xf
    v_add_f32_dpp v178, v178, v178 row_ror:2 row_mask:0xf bank_mask:0xf
    v_add_f32_dpp v179, v179, v179 row_ror:2 row_mask:0xf bank_mask:0xf
    v_add_f32_dpp v176, v176, v176 row_ror:4 row_mask:0xf bank_mask:0xf
    v_add_f32_dpp v177, v177, v177 row_ror:4 row_mask:0xf bank_mask:0xf
    v_add_f32_dpp v178, v178, v178 row_ror:4 row_mask:0xf bank_mask:0xf
    v_add_f32_dpp v179, v179, v179 row_ror:4 row_mask:0xf bank_mask:0xf
    v_add_f32_dpp v176, v176, v176 row_ror:8 row_mask:0xf bank_mask:0xf
    v_add_f32_dpp v177, v177, v177 row_ror:8 row_mask:0xf bank_mask:0xf
    v_add_f32_dpp v178, v178, v178 row_ror:8 row_mask:0xf bank_mask:0xf
    v_add_f32_dpp v179, v179, v179 row_ror:8 row_mask:0xf bank_mask:0xf
    s_lshl_b32 s28, s4, 7
    s_lshl_b32 s29, s5, 10
    s_add_u32 s28, s28, s29
    s_add_u32 s28, s28, 655360
    buffer_store_dwordx4 v[176:179], v10, s[8:11], s28 offen sc1
    s_lshl_b32 s28, s4, 14
    s_add_u32 s28, s28, s29
    s_add_u32 s28, s28, 655360

    s_cmp_lg_u32 s4, 0
    s_cbranch_scc1 L_nored_60

    s_mov_b32 s34, 0
L_poll_63:
    buffer_load_dwordx4 v[192:195], v11, s[8:11], s28 offen sc1
    s_waitcnt vmcnt(0)
    v_max3_u32 v250, v192, v193, v194
    v_max_u32 v250, v250, v195
    v_cmp_eq_u32 vcc, -1, v250
    s_cmp_eq_u64 vcc, 0
    s_cbranch_scc1 L_polld_64

    s_add_u32 s34, s34, 1
    s_cmp_lt_u32 s34, 100000
    s_cbranch_scc1 L_poll_63
L_polld_64:

    v_add_f32_dpp v192, v192, v192 row_ror:2 row_mask:0xf bank_mask:0xf
    v_add_f32_dpp v193, v193, v193 row_ror:2 row_mask:0xf bank_mask:0xf
    v_add_f32_dpp v194, v194, v194 row_ror:2 row_mask:0xf bank_mask:0xf
    v_add_f32_dpp v195, v195, v195 row_ror:2 row_mask:0xf bank_mask:0xf
    v_add_f32_dpp v192, v192, v192 row_ror:4 row_mask:0xf bank_mask:0xf
    v_add_f32_dpp v193, v193, v193 row_ror:4 row_mask:0xf bank_mask:0xf
    v_add_f32_dpp v194, v194, v194 row_ror:4 row_mask:0xf bank_mask:0xf
    v_add_f32_dpp v195, v195, v195 row_ror:4 row_mask:0xf bank_mask:0xf
    v_add_f32_dpp v192, v192, v192 row_ror:8 row_mask:0xf bank_mask:0xf
    v_add_f32_dpp v193, v193, v193 row_ror:8 row_mask:0xf bank_mask:0xf
    v_add_f32_dpp v194, v194, v194 row_ror:8 row_mask:0xf bank_mask:0xf
    v_add_f32_dpp v195, v195, v195 row_ror:8 row_mask:0xf bank_mask:0xf
    v_pk_add_f32 v[16:17], v[16:17], v[192:193]
    v_pk_add_f32 v[18:19], v[18:19], v[194:195]
    v_cvt_pk_bf16_f32 v14, v16, v17
    v_cvt_pk_bf16_f32 v15, v18, v19
    v_lshrrev_b32 v250, 1, v13
    s_mov_b32 exec_lo, 0x00030003
    s_mov_b32 exec_hi, 0x00030003

    s_lshl_b32 s28, s5, 6
    buffer_store_dwordx2 v[14:15], v250, s[20:23], s28 offen
    s_mov_b64 exec, -1
    s_cmp_lg_u32 s2, 0
    s_cbranch_scc1 L_nored_60
    s_add_u32 s50, s50, 1
    v_mov_b32 v251, s50
    v_mov_b32 v250, 0
    s_mov_b64 exec, 1
    buffer_store_dword v251, v250, s[8:11], 0 offen sc1
    s_mov_b64 exec, -1

L_nored_60:
L_only_52:
    s_branch L_wend_18
L_roleF_17:
    s_and_b32 s32, s35, 1
    s_lshr_b32 s33, s35, 1
    s_sub_u32 s30, s5, 16
    s_lshl_b32 s40, s30, 1
    s_add_u32 s40, s40, s32

    s_cmp_ge_u32 s35, 2
    s_cbranch_scc1 L_f23_65

    v_mov_b32 v244, 0
    v_mov_b32 v245, 0
    v_mov_b32 v246, 0
    v_mov_b32 v247, 0
    s_mov_b64 exec, s[36:37]
    buffer_load_dwordx4 v[244:247], v6, s[12:15], 0 offen
    s_mov_b64 exec, -1
    s_lshl_b32 s28, s4, 10
    s_lshl_b32 s29, s30, 6
    s_add_u32 s28, s28, s29
    s_mul_i32 s29, s35, 1835008
    s_add_u32 s28, s28, s29
    s_sub_u32 s29, 3670016, s28

    s_add_u32 s16, s70, s28
    s_addc_u32 s17, s71, 0
    s_mov_b32 s18, s29
    s_mov_b32 s19, 0x00020000

    v_lshrrev_b32 v252, 2, v0
    v_lshlrev_b32 v250, 13, v252
    v_and_b32 v251, 3, v0
    v_lshl_add_u32 v250, v251, 4, v250

    s_mov_b32 s28, 0
    buffer_load_dwordx4 v[176:179], v250, s[16:19], s28 offen
    s_mov_b32 s28, 131072
    buffer_load_dwordx4 v[180:183], v250, s[16:19], s28 offen
    s_mov_b32 s28, 262144
    buffer_load_dwordx4 v[184:187], v250, s[16:19], s28 offen
    s_mov_b32 s28, 393216
    buffer_load_dwordx4 v[188:191], v250, s[16:19], s28 offen
    s_mov_b32 s28, 524288
    buffer_load_dwordx4 v[192:195], v250, s[16:19], s28 offen
    s_mov_b32 s28, 655360
    buffer_load_dwordx4 v[196:199], v250, s[16:19], s28 offen
    s_mov_b32 s28, 786432
    buffer_load_dwordx4 v[200:203], v250, s[16:19], s28 offen
    s_mov_b32 s28, 917504
    buffer_load_dwordx4 v[204:207], v250, s[16:19], s28 offen
    s_mov_b32 s28, 1048576
    buffer_load_dwordx4 v[208:211], v250, s[16:19], s28 offen
    s_mov_b32 s28, 1179648
    buffer_load_dwordx4 v[212:215], v250, s[16:19], s28 offen
    s_mov_b32 s28, 1310720
    buffer_load_dwordx4 v[216:219], v250, s[16:19], s28 offen
    s_mov_b32 s28, 1441792
    buffer_load_dwordx4 v[220:223], v250, s[16:19], s28 offen
    s_mov_b32 s28, 1572864
    buffer_load_dwordx4 v[224:227], v250, s[16:19], s28 offen
    s_mov_b32 s28, 1703936
    buffer_load_dwordx4 v[228:231], v250, s[16:19], s28 offen
    s_barrier
    v_lshrrev_b32 v253, 1, v251
    v_and_b32 v251, 1, v251
    s_movk_i32 s28, 14336
    v_mul_lo_u32 v253, v253, s28
    v_lshl_add_u32 v253, v252, 5, v253
    v_lshl_add_u32 v253, v251, 4, v253
    s_mul_i32 s28, s35, 7168
    s_add_u32 s28, s28, 47104
    v_add_u32 v254, s28, v253

    v_lshlrev_b32 v5, 4, v2
    v_lshrrev_b32 v250, 2, v1
    v_lshl_add_u32 v250, v2, 3, v250
    v_lshlrev_b32 v7, 5, v250
    v_and_b32 v250, 3, v1
    v_lshl_add_u32 v7, v250, 3, v7
    s_mul_i32 s28, s32, 14336
    s_add_u32 s28, s28, 18432
    v_add_u32 v7, s28, v7
    v_lshlrev_b32 v8, 11, v1
    v_lshl_add_u32 v8, v2, 4, v8
    v_lshlrev_b32 v9, 4, v1
    v_and_b32 v250, 1, v1
    v_lshl_add_u32 v250, v2, 1, v250
    v_lshlrev_b32 v13, 4, v250
    v_lshrrev_b32 v251, 1, v1
    v_lshl_add_u32 v12, v251, 11, v13
    v_lshl_add_u32 v10, v251, 14, v13
    v_lshl_add_u32 v11, v251, 7, v13
    v_mov_b32 v240, 0x3f803f80
    v_mov_b32 v241, 0x3f803f80
    v_mov_b32 v242, 0x3f803f80
    v_mov_b32 v243, 0x3f803f80
    s_mov_b32 s45, 0x3b124925
    s_mov_b32 s48, 0x3727c5ac
    s_mov_b32 s49, 0xbfb8aa3b

    v_add_u32 v238, 28672, v7
    s_waitcnt vmcnt(14)

    v_dot2_f32_bf16 v248, v244, v240, 0
    v_dot2_f32_bf16 v249, v244, v244, 0
    v_dot2_f32_bf16 v248, v245, v240, v248
    v_dot2_f32_bf16 v249, v245, v245, v249
    v_dot2_f32_bf16 v248, v246, v240, v248
    v_dot2_f32_bf16 v249, v246, v246, v249
    v_dot2_f32_bf16 v248, v247, v240, v248
    v_dot2_f32_bf16 v249, v247, v247, v249
    s_nop 3
    v_add_f32_dpp v248, v248, v248 row_shr:1 row_mask:0xf bank_mask:0xf bound_ctrl:0
    v_add_f32_dpp v249, v249, v249 row_shr:1 row_mask:0xf bank_mask:0xf bound_ctrl:0
    s_nop 1
    v_add_f32_dpp v248, v248, v248 row_shr:2 row_mask:0xf bank_mask:0xf bound_ctrl:0
    v_add_f32_dpp v249, v249, v249 row_shr:2 row_mask:0xf bank_mask:0xf bound_ctrl:0
    s_nop 1
    v_add_f32_dpp v248, v248, v248 row_shr:4 row_mask:0xf bank_mask:0xf bound_ctrl:0
    v_add_f32_dpp v249, v249, v249 row_shr:4 row_mask:0xf bank_mask:0xf bound_ctrl:0
    s_nop 1
    v_add_f32_dpp v248, v248, v248 row_shr:8 row_mask:0xf bank_mask:0xf bound_ctrl:0
    v_add_f32_dpp v249, v249, v249 row_shr:8 row_mask:0xf bank_mask:0xf bound_ctrl:0
    s_nop 1
    v_add_f32_dpp v248, v248, v248 row_bcast:15 row_mask:0xa bank_mask:0xf
    v_add_f32_dpp v249, v249, v249 row_bcast:15 row_mask:0xa bank_mask:0xf
    s_nop 1
    v_add_f32_dpp v248, v248, v248 row_bcast:31 row_mask:0xc bank_mask:0xf
    v_add_f32_dpp v249, v249, v249 row_bcast:31 row_mask:0xc bank_mask:0xf
    s_nop 1
    v_readlane_b32 s46, v248, 63
    v_readlane_b32 s47, v249, 63
    v_mov_b32 v250, s45
    s_nop 1
    v_mul_f32 v251, s46, v250
    v_mul_f32 v252, s47, v250
    v_fma_f32 v252, -v251, v251, v252
    v_max_f32 v252, 0, v252

    v_add_f32 v252, s48, v252
    v_rsq_f32 v252, v252
    s_nop 0

    v_lshlrev_b32 v248, 16, v244
    v_and_b32 v249, 0xffff0000, v244
    v_sub_f32 v248, v248, v251
    v_sub_f32 v249, v249, v251

    v_mul_f32 v248, v248, v252
    v_mul_f32 v249, v249, v252
    v_cvt_pk_bf16_f32 v244, v248, v249

    v_lshlrev_b32 v248, 16, v245
    v_and_b32 v249, 0xffff0000, v245
    v_sub_f32 v248, v248, v251
    v_sub_f32 v249, v249, v251

    v_mul_f32 v248, v248, v252
    v_mul_f32 v249, v249, v252
    v_cvt_pk_bf16_f32 v245, v248, v249

    v_lshlrev_b32 v248, 16, v246
    v_and_b32 v249, 0xffff0000, v246
    v_sub_f32 v248, v248, v251
    v_sub_f32 v249, v249, v251

    v_mul_f32 v248, v248, v252
    v_mul_f32 v249, v249, v252
    v_cvt_pk_bf16_f32 v246, v248, v249

    v_lshlrev_b32 v248, 16, v247
    v_and_b32 v249, 0xffff0000, v247
    v_sub_f32 v248, v248, v251
    v_sub_f32 v249, v249, v251

    v_mul_f32 v248, v248, v252
    v_mul_f32 v249, v249, v252
    v_cvt_pk_bf16_f32 v247, v248, v249

    s_mov_b64 exec, s[36:37]
    ds_write_b128 v6, v[244:247] offset:0
    s_mov_b64 exec, -1

    s_waitcnt vmcnt(13)
    ds_write_b128 v254, v[176:179] offset:0
    s_waitcnt vmcnt(12)
    ds_write_b128 v254, v[180:183] offset:512
    s_waitcnt vmcnt(11)
    ds_write_b128 v254, v[184:187] offset:1024
    s_waitcnt vmcnt(10)
    ds_write_b128 v254, v[188:191] offset:1536
    s_waitcnt vmcnt(9)
    ds_write_b128 v254, v[192:195] offset:2048
    s_waitcnt vmcnt(8)
    ds_write_b128 v254, v[196:199] offset:2560
    s_waitcnt vmcnt(7)
    ds_write_b128 v254, v[200:203] offset:3072
    s_waitcnt vmcnt(6)
    ds_write_b128 v254, v[204:207] offset:3584
    s_waitcnt lgkmcnt(0)
    s_waitcnt vmcnt(5)
    ds_write_b128 v254, v[208:211] offset:4096
    s_waitcnt vmcnt(4)
    ds_write_b128 v254, v[212:215] offset:4608
    s_waitcnt vmcnt(3)
    ds_write_b128 v254, v[216:219] offset:5120
    s_waitcnt vmcnt(2)
    ds_write_b128 v254, v[220:223] offset:5632
    s_waitcnt vmcnt(1)
    ds_write_b128 v254, v[224:227] offset:6144
    s_waitcnt vmcnt(0)
    ds_write_b128 v254, v[228:231] offset:6656
    s_waitcnt lgkmcnt(0)
    s_mul_i32 s6, s50, 0x9E3779B1
    s_add_u32 s6, s6, 0x7F4A7C15
    s_lshl_b32 s28, s35, 2
    s_add_u32 s28, s28, 4104
    v_mov_b32 v250, s28
    v_mov_b32 v251, 1
    ds_write_b32 v250, v251
    v_xor_b32 v250, 4, v250
    s_mov_b32 s34, 0
L_spin_67:
    ds_read_b32 v251, v250
    s_waitcnt lgkmcnt(0)
    v_readfirstlane_b32 s28, v251
    s_cmp_eq_u32 s28, 1
    s_cbranch_scc1 L_spind_68
    s_add_u32 s34, s34, 1
    s_cmp_lt_u32 s34, 800000
    s_cbranch_scc1 L_spin_67
L_spind_68:

    ds_read_b64_tr_b16 v[72:73], v238 offset:0
    ds_read_b64_tr_b16 v[74:75], v238 offset:128
    ds_read_b64_tr_b16 v[76:77], v238 offset:1024
    ds_read_b64_tr_b16 v[78:79], v238 offset:1152
    ds_read_b64_tr_b16 v[80:81], v238 offset:2048
    ds_read_b64_tr_b16 v[82:83], v238 offset:2176
    ds_read_b64_tr_b16 v[84:85], v238 offset:3072
    ds_read_b64_tr_b16 v[86:87], v238 offset:3200
    s_waitcnt lgkmcnt(0)
    ds_read_b64_tr_b16 v[88:89], v238 offset:4096
    ds_read_b64_tr_b16 v[90:91], v238 offset:4224
    ds_read_b64_tr_b16 v[92:93], v238 offset:5120
    ds_read_b64_tr_b16 v[94:95], v238 offset:5248
    ds_read_b64_tr_b16 v[96:97], v238 offset:6144
    ds_read_b64_tr_b16 v[98:99], v238 offset:6272
    ds_read_b64_tr_b16 v[100:101], v238 offset:7168
    ds_read_b64_tr_b16 v[102:103], v238 offset:7296
    s_waitcnt lgkmcnt(0)
    ds_read_b64_tr_b16 v[104:105], v238 offset:8192
    ds_read_b64_tr_b16 v[106:107], v238 offset:8320
    ds_read_b64_tr_b16 v[108:109], v238 offset:9216
    ds_read_b64_tr_b16 v[110:111], v238 offset:9344
    ds_read_b64_tr_b16 v[112:113], v238 offset:10240
    ds_read_b64_tr_b16 v[114:115], v238 offset:10368
    ds_read_b64_tr_b16 v[116:117], v238 offset:11264
    ds_read_b64_tr_b16 v[118:119], v238 offset:11392
    s_waitcnt lgkmcnt(0)
    ds_read_b64_tr_b16 v[120:121], v238 offset:12288
    ds_read_b64_tr_b16 v[122:123], v238 offset:12416
    ds_read_b64_tr_b16 v[124:125], v238 offset:13312
    ds_read_b64_tr_b16 v[126:127], v238 offset:13440
    s_waitcnt lgkmcnt(0)
    ds_read_b128 v[176:179], v5 offset:0
    ds_read_b128 v[180:183], v5 offset:64
    ds_read_b128 v[184:187], v5 offset:128
    ds_read_b128 v[188:191], v5 offset:192
    ds_read_b128 v[192:195], v5 offset:256
    ds_read_b128 v[196:199], v5 offset:320
    ds_read_b128 v[200:203], v5 offset:384
    ds_read_b128 v[204:207], v5 offset:448
    ds_read_b128 v[208:211], v5 offset:512
    ds_read_b128 v[212:215], v5 offset:576
    ds_read_b128 v[216:219], v5 offset:640
    ds_read_b128 v[220:223], v5 offset:704
    ds_read_b128 v[224:227], v5 offset:768
    ds_read_b128 v[228:231], v5 offset:832
    s_waitcnt lgkmcnt(13)
    v_mfma_f32_16x16x32_bf16 v[232:235], v[176:179], v[72:75], 0
    s_waitcnt lgkmcnt(12)
    v_mfma_f32_16x16x32_bf16 v[232:235], v[180:183], v[76:79], v[232:235]
    s_waitcnt lgkmcnt(11)
    v_mfma_f32_16x16x32_bf16 v[232:235], v[184:187], v[80:83], v[232:235]
    s_waitcnt lgkmcnt(10)
    v_mfma_f32_16x16x32_bf16 v[232:235], v[188:191], v[84:87], v[232:235]
    s_waitcnt lgkmcnt(9)
    v_mfma_f32_16x16x32_bf16 v[232:235], v[192:195], v[88:91], v[232:235]
    s_waitcnt lgkmcnt(8)
    v_mfma_f32_16x16x32_bf16 v[232:235], v[196:199], v[92:95], v[232:235]
    s_waitcnt lgkmcnt(7)
    v_mfma_f32_16x16x32_bf16 v[232:235], v[200:203], v[96:99], v[232:235]
    s_waitcnt lgkmcnt(6)
    v_mfma_f32_16x16x32_bf16 v[232:235], v[204:207], v[100:103], v[232:235]
    s_waitcnt lgkmcnt(5)
    v_mfma_f32_16x16x32_bf16 v[232:235], v[208:211], v[104:107], v[232:235]
    s_waitcnt lgkmcnt(4)
    v_mfma_f32_16x16x32_bf16 v[232:235], v[212:215], v[108:111], v[232:235]
    s_waitcnt lgkmcnt(3)
    v_mfma_f32_16x16x32_bf16 v[232:235], v[216:219], v[112:115], v[232:235]
    s_waitcnt lgkmcnt(2)
    v_mfma_f32_16x16x32_bf16 v[232:235], v[220:223], v[116:119], v[232:235]
    s_waitcnt lgkmcnt(1)
    v_mfma_f32_16x16x32_bf16 v[232:235], v[224:227], v[120:123], v[232:235]
    s_waitcnt lgkmcnt(0)
    v_mfma_f32_16x16x32_bf16 v[232:235], v[228:231], v[124:127], v[232:235]
    s_nop 7
    v_mov_b32 v254, v232
    s_nop 1
    v_mov_b32_dpp v253, v254 quad_perm:[1,0,3,2] row_mask:0xf bank_mask:0xf
    v_mov_b32 v15, s6
    v_cvt_pk_bf16_f32 v14, v254, v253
    v_lshlrev_b32 v250, 2, v0
    s_lshl_b32 s28, s4, 11
    s_lshl_b32 s29, s40, 6
    s_add_u32 s28, s28, s29
    s_add_u32 s28, s28, 8192
    s_mov_b64 exec, 0x5555

    buffer_store_dwordx2 v[14:15], v250, s[8:11], s28 offen sc1
    s_mov_b64 exec, -1
    s_lshl_b32 s28, s35, 2
    s_add_u32 s28, s28, 4112
    v_mov_b32 v250, s28
    v_mov_b32 v251, 1
    s_waitcnt vmcnt(0)
    ds_write_b32 v250, v251

    v_mfma_f32_16x16x32_bf16 v[232:235], v[240:243], v[72:75], 0
    v_mfma_f32_16x16x32_bf16 v[232:235], v[240:243], v[76:79], v[232:235]
    v_mfma_f32_16x16x32_bf16 v[232:235], v[240:243], v[80:83], v[232:235]
    v_mfma_f32_16x16x32_bf16 v[232:235], v[240:243], v[84:87], v[232:235]
    v_mfma_f32_16x16x32_bf16 v[232:235], v[240:243], v[88:91], v[232:235]
    v_mfma_f32_16x16x32_bf16 v[232:235], v[240:243], v[92:95], v[232:235]
    v_mfma_f32_16x16x32_bf16 v[232:235], v[240:243], v[96:99], v[232:235]
    v_mfma_f32_16x16x32_bf16 v[232:235], v[240:243], v[100:103], v[232:235]
    v_mfma_f32_16x16x32_bf16 v[232:235], v[240:243], v[104:107], v[232:235]
    v_mfma_f32_16x16x32_bf16 v[232:235], v[240:243], v[108:111], v[232:235]
    v_mfma_f32_16x16x32_bf16 v[232:235], v[240:243], v[112:115], v[232:235]
    v_mfma_f32_16x16x32_bf16 v[232:235], v[240:243], v[116:119], v[232:235]
    v_mfma_f32_16x16x32_bf16 v[232:235], v[240:243], v[120:123], v[232:235]
    v_mfma_f32_16x16x32_bf16 v[232:235], v[240:243], v[124:127], v[232:235]
    s_nop 7
    v_mov_b32 v237, v232
    s_branch L_fj_66
L_f23_65:
    s_cmp_lg_u32 s35, 3
    s_cbranch_scc1 L_only_69

    v_mov_b32 v176, -1
    v_mov_b32 v177, -1
    v_mov_b32 v178, -1
    v_mov_b32 v179, -1
    s_lshl_b32 s28, s4, 16
    s_lshl_b32 s29, s5, 11
    s_add_u32 s28, s28, s29

    s_add_u32 s29, s28, 1048576
    buffer_store_dwordx4 v[176:179], v6, s[8:11], s29 offen sc1
    buffer_store_dwordx4 v[176:179], v6, s[8:11], s29 offen offset:1024 sc1
    s_add_u32 s29, s28, 1572864
    buffer_store_dwordx4 v[176:179], v6, s[8:11], s29 offen sc1
    buffer_store_dwordx4 v[176:179], v6, s[8:11], s29 offen offset:1024 sc1
    s_cmp_ge_u32 s5, 30
    s_cbranch_scc1 L_noy_70
    s_sub_u32 s30, s5, 16
    s_lshl_b32 s30, s30, 12
    s_lshl_b32 s31, s4, 16
    s_add_u32 s30, s30, s31

    s_add_u32 s29, s30, 2621440
    buffer_store_dwordx4 v[176:179], v6, s[8:11], s29 offen sc1
    buffer_store_dwordx4 v[176:179], v6, s[8:11], s29 offen offset:1024 sc1
    s_add_u32 s29, s30, 2623488
    buffer_store_dwordx4 v[176:179], v6, s[8:11], s29 offen sc1
    buffer_store_dwordx4 v[176:179], v6, s[8:11], s29 offen offset:1024 sc1
    s_add_u32 s29, s30, 3670016
    buffer_store_dwordx4 v[176:179], v6, s[8:11], s29 offen sc1
    buffer_store_dwordx4 v[176:179], v6, s[8:11], s29 offen offset:1024 sc1
    s_add_u32 s29, s30, 3672064
    buffer_store_dwordx4 v[176:179], v6, s[8:11], s29 offen sc1
    buffer_store_dwordx4 v[176:179], v6, s[8:11], s29 offen offset:1024 sc1
L_noy_70:
    s_lshl_b32 s28, s4, 9
    s_lshl_b32 s29, s5, 4
    s_add_u32 s28, s28, s29
    s_mov_b64 exec, 1

    s_add_u32 s29, s28, 40960
    buffer_store_dwordx4 v[176:179], v6, s[8:11], s29 offen sc1
    s_add_u32 s29, s28, 45056
    buffer_store_dwordx4 v[176:179], v6, s[8:11], s29 offen sc1
    s_mov_b64 exec, -1
L_only_69:
    s_barrier
    v_lshlrev_b32 v5, 4, v2
    v_lshrrev_b32 v250, 2, v1
    v_lshl_add_u32 v250, v2, 3, v250
    v_lshlrev_b32 v7, 5, v250
    v_and_b32 v250, 3, v1
    v_lshl_add_u32 v7, v250, 3, v7
    s_mul_i32 s28, s32, 14336
    s_add_u32 s28, s28, 18432
    v_add_u32 v7, s28, v7
    v_lshlrev_b32 v8, 11, v1
    v_lshl_add_u32 v8, v2, 4, v8
    v_lshlrev_b32 v9, 4, v1
    v_and_b32 v250, 1, v1
    v_lshl_add_u32 v250, v2, 1, v250
    v_lshlrev_b32 v13, 4, v250
    v_lshrrev_b32 v251, 1, v1
    v_lshl_add_u32 v12, v251, 11, v13
    v_lshl_add_u32 v10, v251, 14, v13
    v_lshl_add_u32 v11, v251, 7, v13
    v_mov_b32 v240, 0x3f803f80
    v_mov_b32 v241, 0x3f803f80
    v_mov_b32 v242, 0x3f803f80
    v_mov_b32 v243, 0x3f803f80
    s_mov_b32 s45, 0x3b124925
    s_mov_b32 s48, 0x3727c5ac
    s_mov_b32 s49, 0xbfb8aa3b

    s_cmp_lg_u32 s35, 3
    s_cbranch_scc1 L_only_71

    s_waitcnt lgkmcnt(0)
    s_mul_i32 s6, s50, 0x9E3779B1
    s_add_u32 s6, s6, 0x7F4A7C15
    s_getreg_b32 s51, hwreg(HW_REG_XCC_ID)
    s_and_b32 s51, s51, 15
    s_or_b32 s51, s51, 0x100
    v_mov_b32 v14, s51
    v_mov_b32 v15, s6
    v_mov_b32 v250, 0
    s_lshl_b32 s28, s2, 3
    s_add_u32 s28, s28, 4096
    s_waitcnt vmcnt(0)
    s_mov_b64 exec, 1
    buffer_store_dwordx2 v[14:15], v250, s[8:11], s28 offen sc1
    s_mov_b64 exec, -1

L_only_71:
L_fj_66:
    s_sub_u32 s30, s5, 16
    s_mul_i32 s28, s4, 448
    s_lshl_b32 s29, s30, 5
    s_add_u32 s28, s28, s29
    s_sub_u32 s29, 1605632, s28
    s_cmp_lt_u32 s5, 30
    s_cselect_b32 s28, s28, 0
    s_cselect_b32 s29, s29, 0
    s_cmp_eq_u32 s32, 0
    s_cselect_b32 s16, s76, s78
    s_cselect_b32 s17, s77, s79
    s_add_u32 s16, s16, s28
    s_addc_u32 s17, s17, 0
    s_mov_b32 s18, s29
    s_mov_b32 s19, 0x00020000
    s_mul_i32 s28, s4, 224
    s_lshl_b32 s29, s30, 4
    s_add_u32 s28, s28, s29
    s_lshl_b32 s29, s32, 3
    s_add_u32 s28, s28, s29
    s_mul_i32 s28, s28, 896
    s_cmp_lt_u32 s5, 30
    s_cselect_b32 s28, s28, 0
    s_cselect_b32 s29, 7168, 0

    s_add_u32 s24, s80, s28
    s_addc_u32 s25, s81, 0
    s_mov_b32 s26, s29
    s_mov_b32 s27, 0x00020000

    v_lshrrev_b32 v250, 1, v0
    s_mul_i32 s28, s33, 224
    v_add_u32 v250, s28, v250
    s_movk_i32 s28, 3584
    v_mul_lo_u32 v8, v250, s28
    v_and_b32 v251, 1, v0
    v_lshl_add_u32 v8, v251, 4, v8
    s_movk_i32 s28, 14336
    v_mul_lo_u32 v9, v251, s28
    v_lshl_add_u32 v9, v250, 5, v9
    s_lshl_b32 s28, s32, 4
    s_add_u32 s28, s28, 18432
    v_add_u32 v9, s28, v9
    s_mul_i32 s28, s33, 448
    v_lshlrev_b32 v4, 3, v0
    v_add_u32 v4, s28, v4
    v_lshlrev_b32 v3, 1, v4
    s_waitcnt lgkmcnt(0)

    s_barrier
    s_cmp_lg_u32 s35, 3
    s_cbranch_scc1 L_only_72

    s_movk_i32 s28, 4096
    s_mov_b32 s34, 0
L_poll_73:
    buffer_load_dwordx4 v[176:179], v6, s[8:11], s28 offen sc1
    buffer_load_dwordx4 v[180:183], v6, s[8:11], s28 offen offset:1024 sc1
    s_waitcnt vmcnt(0)
    v_xor_b32 v250, s6, v177
    v_xor_b32 v251, s6, v179
    v_xor_b32 v252, s6, v181
    v_xor_b32 v253, s6, v183
    v_or3_b32 v250, v250, v251, v252
    v_or_b32 v250, v250, v253
    v_cmp_ne_u32 vcc, 0, v250

    s_cmp_eq_u64 vcc, 0
    s_cbranch_scc1 L_polld_74
    s_sleep 2
    s_add_u32 s34, s34, 1
    s_cmp_lt_u32 s34, 100000
    s_cbranch_scc1 L_poll_73
L_polld_74:

    v_lshlrev_b32 v250, 1, v0
    v_and_b32 v250, 7, v250
    v_or_b32 v251, 1, v250
    v_cmp_eq_u32 s[52:53], s4, v250
    v_cmp_eq_u32 s[54:55], s4, v251
    v_cmp_ne_u32 s[56:57], s51, v176
    v_cmp_ne_u32 s[58:59], s51, v180
    v_cmp_ne_u32 s[60:61], s51, v178
    v_cmp_ne_u32 s[62:63], s51, v182
    s_or_b64 s[56:57], s[56:57], s[58:59]
    s_or_b64 s[60:61], s[60:61], s[62:63]
    s_and_b64 s[56:57], s[56:57], s[52:53]
    s_and_b64 s[60:61], s[60:61], s[54:55]
    s_or_b64 s[56:57], s[56:57], s[60:61]
    s_cmp_eq_u64 s[56:57], 0
    s_cselect_b32 s7, 1, 0
    v_mov_b32 v250, 4096
    v_mov_b32 v251, s7
    ds_write_b32 v250, v251 offset:4
    s_waitcnt lgkmcnt(0)

L_only_72:
    s_mov_b32 s28, 0
    buffer_load_dwordx4 v[176:179], v8, s[16:19], s28 offen
    s_mov_b32 s28, 114688
    buffer_load_dwordx4 v[180:183], v8, s[16:19], s28 offen
    s_barrier
    v_mov_b32 v250, 4096
    ds_read_b32 v251, v250 offset:4
    s_waitcnt lgkmcnt(0)
    v_readfirstlane_b32 s7, v251

    s_barrier
    s_mov_b32 s28, 229376
    buffer_load_dwordx4 v[184:187], v8, s[16:19], s28 offen
    s_mov_b32 s28, 344064
    buffer_load_dwordx4 v[188:191], v8, s[16:19], s28 offen
    s_mov_b32 s28, 458752
    buffer_load_dwordx4 v[192:195], v8, s[16:19], s28 offen
    s_mov_b32 s28, 573440
    buffer_load_dwordx4 v[196:199], v8, s[16:19], s28 offen
    s_mov_b32 s28, 688128
    buffer_load_dwordx4 v[200:203], v8, s[16:19], s28 offen
    s_mov_b64 exec, s[36:37]
    s_movk_i32 s28, 0
    buffer_load_dwordx2 v[130:131], v4, s[24:27], s28 offen
    s_mov_b64 exec, -1
    s_mov_b64 exec, s[36:37]
    s_movk_i32 s28, 896
    buffer_load_dwordx2 v[134:135], v4, s[24:27], s28 offen
    s_mov_b64 exec, -1
    s_mov_b64 exec, s[36:37]
    s_movk_i32 s28, 1792
    buffer_load_dwordx2 v[138:139], v4, s[24:27], s28 offen
    s_mov_b64 exec, -1
    s_mov_b64 exec, s[36:37]
    s_movk_i32 s28, 2688
    buffer_load_dwordx2 v[142:143], v4, s[24:27], s28 offen
    s_mov_b64 exec, -1
    s_mov_b64 exec, s[36:37]
    s_movk_i32 s28, 3584
    buffer_load_dwordx2 v[146:147], v4, s[24:27], s28 offen
    s_mov_b64 exec, -1
    s_mov_b64 exec, s[36:37]
    s_movk_i32 s28, 4480
    buffer_load_dwordx2 v[150:151], v4, s[24:27], s28 offen
    s_mov_b64 exec, -1
    s_mov_b64 exec, s[36:37]
    s_movk_i32 s28, 5376
    buffer_load_dwordx2 v[154:155], v4, s[24:27], s28 offen
    s_mov_b64 exec, -1
    s_mov_b64 exec, s[36:37]
    s_movk_i32 s28, 6272
    buffer_load_dwordx2 v[158:159], v4, s[24:27], s28 offen
    s_mov_b64 exec, -1
    s_waitcnt vmcnt(14)
    ds_write_b128 v9, v[176:179] offset:0
    s_waitcnt vmcnt(13)
    ds_write_b128 v9, v[180:183] offset:1024
    s_waitcnt vmcnt(12)
    ds_write_b128 v9, v[184:187] offset:2048
    s_waitcnt vmcnt(11)
    ds_write_b128 v9, v[188:191] offset:3072
    s_waitcnt vmcnt(10)
    ds_write_b128 v9, v[192:195] offset:4096
    s_waitcnt vmcnt(9)
    ds_write_b128 v9, v[196:199] offset:5120
    s_waitcnt vmcnt(8)
    ds_write_b128 v9, v[200:203] offset:6144
    s_waitcnt vmcnt(0)
    v_lshlrev_b32 v128, 16, v130
    v_and_b32 v129, 0xffff0000, v130
    v_lshlrev_b32 v130, 16, v131
    v_and_b32 v131, 0xffff0000, v131

    v_lshlrev_b32 v132, 16, v134
    v_and_b32 v133, 0xffff0000, v134
    v_lshlrev_b32 v134, 16, v135
    v_and_b32 v135, 0xffff0000, v135

    v_lshlrev_b32 v136, 16, v138
    v_and_b32 v137, 0xffff0000, v138
    v_lshlrev_b32 v138, 16, v139
    v_and_b32 v139, 0xffff0000, v139

    v_lshlrev_b32 v140, 16, v142
    v_and_b32 v141, 0xffff0000, v142
    v_lshlrev_b32 v142, 16, v143
    v_and_b32 v143, 0xffff0000, v143

    v_lshlrev_b32 v144, 16, v146
    v_and_b32 v145, 0xffff0000, v146
    v_lshlrev_b32 v146, 16, v147
    v_and_b32 v147, 0xffff0000, v147

    v_lshlrev_b32 v148, 16, v150
    v_and_b32 v149, 0xffff0000, v150
    v_lshlrev_b32 v150, 16, v151
    v_and_b32 v151, 0xffff0000, v151

    v_lshlrev_b32 v152, 16, v154
    v_and_b32 v153, 0xffff0000, v154
    v_lshlrev_b32 v154, 16, v155
    v_and_b32 v155, 0xffff0000, v155

    v_lshlrev_b32 v156, 16, v158
    v_and_b32 v157, 0xffff0000, v158
    v_lshlrev_b32 v158, 16, v159
    v_and_b32 v159, 0xffff0000, v159

    s_waitcnt lgkmcnt(0)
    s_barrier
    ds_read_b64_tr_b16 v[16:17], v7 offset:0
    ds_read_b64_tr_b16 v[18:19], v7 offset:128
    ds_read_b64_tr_b16 v[20:21], v7 offset:1024
    ds_read_b64_tr_b16 v[22:23], v7 offset:1152
    ds_read_b64_tr_b16 v[24:25], v7 offset:2048
    ds_read_b64_tr_b16 v[26:27], v7 offset:2176
    ds_read_b64_tr_b16 v[28:29], v7 offset:3072
    ds_read_b64_tr_b16 v[30:31], v7 offset:3200
    s_waitcnt lgkmcnt(0)
    ds_read_b64_tr_b16 v[32:33], v7 offset:4096
    ds_read_b64_tr_b16 v[34:35], v7 offset:4224
    ds_read_b64_tr_b16 v[36:37], v7 offset:5120
    ds_read_b64_tr_b16 v[38:39], v7 offset:5248
    ds_read_b64_tr_b16 v[40:41], v7 offset:6144
    ds_read_b64_tr_b16 v[42:43], v7 offset:6272
    ds_read_b64_tr_b16 v[44:45], v7 offset:7168
    ds_read_b64_tr_b16 v[46:47], v7 offset:7296
    s_waitcnt lgkmcnt(0)
    ds_read_b64_tr_b16 v[48:49], v7 offset:8192
    ds_read_b64_tr_b16 v[50:51], v7 offset:8320
    ds_read_b64_tr_b16 v[52:53], v7 offset:9216
    ds_read_b64_tr_b16 v[54:55], v7 offset:9344
    ds_read_b64_tr_b16 v[56:57], v7 offset:10240
    ds_read_b64_tr_b16 v[58:59], v7 offset:10368
    ds_read_b64_tr_b16 v[60:61], v7 offset:11264
    ds_read_b64_tr_b16 v[62:63], v7 offset:11392
    s_waitcnt lgkmcnt(0)
    ds_read_b64_tr_b16 v[64:65], v7 offset:12288
    ds_read_b64_tr_b16 v[66:67], v7 offset:12416
    ds_read_b64_tr_b16 v[68:69], v7 offset:13312
    ds_read_b64_tr_b16 v[70:71], v7 offset:13440
    s_waitcnt lgkmcnt(0)
    v_mfma_f32_16x16x32_bf16 v[232:235], v[240:243], v[16:19], 0
    v_mfma_f32_16x16x32_bf16 v[232:235], v[240:243], v[20:23], v[232:235]
    v_mfma_f32_16x16x32_bf16 v[232:235], v[240:243], v[24:27], v[232:235]
    v_mfma_f32_16x16x32_bf16 v[232:235], v[240:243], v[28:31], v[232:235]
    v_mfma_f32_16x16x32_bf16 v[232:235], v[240:243], v[32:35], v[232:235]
    v_mfma_f32_16x16x32_bf16 v[232:235], v[240:243], v[36:39], v[232:235]
    v_mfma_f32_16x16x32_bf16 v[232:235], v[240:243], v[40:43], v[232:235]
    v_mfma_f32_16x16x32_bf16 v[232:235], v[240:243], v[44:47], v[232:235]
    v_mfma_f32_16x16x32_bf16 v[232:235], v[240:243], v[48:51], v[232:235]
    v_mfma_f32_16x16x32_bf16 v[232:235], v[240:243], v[52:55], v[232:235]
    v_mfma_f32_16x16x32_bf16 v[232:235], v[240:243], v[56:59], v[232:235]
    v_mfma_f32_16x16x32_bf16 v[232:235], v[240:243], v[60:63], v[232:235]
    v_mfma_f32_16x16x32_bf16 v[232:235], v[240:243], v[64:67], v[232:235]
    v_mfma_f32_16x16x32_bf16 v[232:235], v[240:243], v[68:71], v[232:235]
    s_nop 7
    v_mov_b32 v236, v232
    s_cmp_ge_u32 s5, 30
    s_cbranch_scc1 L_nox_75

    s_cmp_lg_u32 s35, 2
    s_cbranch_scc1 L_only_76

    s_lshl_b32 s28, s4, 10
    s_add_u32 s28, s28, 131072
    s_mov_b64 exec, s[36:37]

    s_mov_b32 s34, 0
L_poll_77:
    buffer_load_dwordx4 v[176:179], v6, s[8:11], s28 offen sc1
    s_waitcnt vmcnt(0)
    v_max3_u32 v250, v176, v177, v178
    v_max_u32 v250, v250, v179
    v_cmp_eq_u32 vcc, -1, v250
    s_cmp_eq_u64 vcc, 0
    s_cbranch_scc1 L_polld_78

    s_add_u32 s34, s34, 1
    s_cmp_lt_u32 s34, 100000
    s_cbranch_scc1 L_poll_77
L_polld_78:

    ds_write_b128 v6, v[176:179] offset:1024
    s_mov_b64 exec, -1
    s_waitcnt lgkmcnt(0)

L_only_76:
L_nox_75:
    s_barrier
    s_cmp_ge_u32 s5, 30
    s_cbranch_scc1 L_noffn_79

    v_mov_b32 v244, 0
    v_mov_b32 v245, 0
    v_mov_b32 v246, 0
    v_mov_b32 v247, 0
    s_mov_b64 exec, s[36:37]
    ds_read_b128 v[244:247], v6 offset:1024
    s_mov_b64 exec, -1

    ds_read_b128 v[176:179], v5 offset:1024
    ds_read_b128 v[180:183], v5 offset:1088
    ds_read_b128 v[184:187], v5 offset:1152
    ds_read_b128 v[188:191], v5 offset:1216
    ds_read_b128 v[192:195], v5 offset:1280
    ds_read_b128 v[196:199], v5 offset:1344
    ds_read_b128 v[200:203], v5 offset:1408
    ds_read_b128 v[204:207], v5 offset:1472
    ds_read_b128 v[208:211], v5 offset:1536
    ds_read_b128 v[212:215], v5 offset:1600
    ds_read_b128 v[216:219], v5 offset:1664
    ds_read_b128 v[220:223], v5 offset:1728
    ds_read_b128 v[224:227], v5 offset:1792
    ds_read_b128 v[228:231], v5 offset:1856
    s_waitcnt lgkmcnt(14)
    s_waitcnt lgkmcnt(13)
    v_mfma_f32_16x16x32_bf16 v[232:235], v[176:179], v[16:19], 0
    v_dot2_f32_bf16 v248, v244, v240, 0
    v_dot2_f32_bf16 v249, v244, v244, 0
    v_dot2_f32_bf16 v248, v245, v240, v248
    s_waitcnt lgkmcnt(12)
    v_mfma_f32_16x16x32_bf16 v[232:235], v[180:183], v[20:23], v[232:235]
    v_dot2_f32_bf16 v249, v245, v245, v249
    v_dot2_f32_bf16 v248, v246, v240, v248
    v_dot2_f32_bf16 v249, v246, v246, v249
    s_waitcnt lgkmcnt(11)
    v_mfma_f32_16x16x32_bf16 v[232:235], v[184:187], v[24:27], v[232:235]
    v_dot2_f32_bf16 v248, v247, v240, v248
    v_dot2_f32_bf16 v249, v247, v247, v249
    s_nop 2
    s_waitcnt lgkmcnt(10)
    v_mfma_f32_16x16x32_bf16 v[232:235], v[188:191], v[28:31], v[232:235]
    v_add_f32_dpp v248, v248, v248 row_shr:1 row_mask:0xf bank_mask:0xf bound_ctrl:0
    v_add_f32_dpp v249, v249, v249 row_shr:1 row_mask:0xf bank_mask:0xf bound_ctrl:0
    s_nop 0
    s_waitcnt lgkmcnt(9)
    v_mfma_f32_16x16x32_bf16 v[232:235], v[192:195], v[32:35], v[232:235]
    v_add_f32_dpp v248, v248, v248 row_shr:2 row_mask:0xf bank_mask:0xf bound_ctrl:0
    v_add_f32_dpp v249, v249, v249 row_shr:2 row_mask:0xf bank_mask:0xf bound_ctrl:0
    s_nop 0
    s_waitcnt lgkmcnt(8)
    v_mfma_f32_16x16x32_bf16 v[232:235], v[196:199], v[36:39], v[232:235]
    v_add_f32_dpp v248, v248, v248 row_shr:4 row_mask:0xf bank_mask:0xf bound_ctrl:0
    v_add_f32_dpp v249, v249, v249 row_shr:4 row_mask:0xf bank_mask:0xf bound_ctrl:0
    s_nop 0
    s_waitcnt lgkmcnt(7)
    v_mfma_f32_16x16x32_bf16 v[232:235], v[200:203], v[40:43], v[232:235]
    v_add_f32_dpp v248, v248, v248 row_shr:8 row_mask:0xf bank_mask:0xf bound_ctrl:0
    v_add_f32_dpp v249, v249, v249 row_shr:8 row_mask:0xf bank_mask:0xf bound_ctrl:0
    s_nop 0
    s_waitcnt lgkmcnt(6)
    v_mfma_f32_16x16x32_bf16 v[232:235], v[204:207], v[44:47], v[232:235]
    v_add_f32_dpp v248, v248, v248 row_bcast:15 row_mask:0xa bank_mask:0xf
    v_add_f32_dpp v249, v249, v249 row_bcast:15 row_mask:0xa bank_mask:0xf
    s_nop 0
    s_waitcnt lgkmcnt(5)
    v_mfma_f32_16x16x32_bf16 v[232:235], v[208:211], v[48:51], v[232:235]
    v_add_f32_dpp v248, v248, v248 row_bcast:31 row_mask:0xc bank_mask:0xf
    v_add_f32_dpp v249, v249, v249 row_bcast:31 row_mask:0xc bank_mask:0xf
    s_nop 0
    s_waitcnt lgkmcnt(4)
    v_mfma_f32_16x16x32_bf16 v[232:235], v[212:215], v[52:55], v[232:235]
    v_readlane_b32 s46, v248, 63
    v_readlane_b32 s47, v249, 63
    v_mov_b32 v250, s45
    s_nop 0
    s_waitcnt lgkmcnt(3)
    v_mfma_f32_16x16x32_bf16 v[232:235], v[216:219], v[56:59], v[232:235]
    v_mul_f32 v251, s46, v250
    v_mul_f32 v252, s47, v250
    v_fma_f32 v252, -v251, v251, v252
    v_max_f32 v252, 0, v252
    s_waitcnt lgkmcnt(2)
    v_mfma_f32_16x16x32_bf16 v[232:235], v[220:223], v[60:63], v[232:235]
    v_add_f32 v252, s48, v252
    v_rsq_f32 v252, v252
    s_waitcnt lgkmcnt(1)
    v_mfma_f32_16x16x32_bf16 v[232:235], v[224:227], v[64:67], v[232:235]
    s_waitcnt lgkmcnt(0)
    v_mfma_f32_16x16x32_bf16 v[232:235], v[228:231], v[68:71], v[232:235]
    s_nop 7
    v_fma_f32 v254, -v251, v236, v232
    v_mul_f32 v254, v254, v252

    v_mul_f32 v250, s49, v254
    v_exp_f32 v250, v250
    v_mov_b32_dpp v253, v254 row_ror:8 row_mask:0xf bank_mask:0xf
    v_add_f32 v250, 1.0, v250
    v_rcp_f32 v250, v250
    s_nop 0
    v_mul_f32 v250, v250, v254

    v_mul_f32 v250, v250, v253
    v_mov_b32 v244, 0
    v_mov_b32 v245, 0
    v_mov_b32 v246, 0
    v_mov_b32 v247, 0

    v_fmac_f32_dpp v244, v250, v128 row_newbcast:0 row_mask:0xf bank_mask:0xf
    v_fmac_f32_dpp v245, v250, v129 row_newbcast:0 row_mask:0xf bank_mask:0xf
    v_fmac_f32_dpp v246, v250, v130 row_newbcast:0 row_mask:0xf bank_mask:0xf
    v_fmac_f32_dpp v247, v250, v131 row_newbcast:0 row_mask:0xf bank_mask:0xf
    v_fmac_f32_dpp v244, v250, v132 row_newbcast:1 row_mask:0xf bank_mask:0xf
    v_fmac_f32_dpp v245, v250, v133 row_newbcast:1 row_mask:0xf bank_mask:0xf
    v_fmac_f32_dpp v246, v250, v134 row_newbcast:1 row_mask:0xf bank_mask:0xf
    v_fmac_f32_dpp v247, v250, v135 row_newbcast:1 row_mask:0xf bank_mask:0xf
    v_fmac_f32_dpp v244, v250, v136 row_newbcast:2 row_mask:0xf bank_mask:0xf
    v_fmac_f32_dpp v245, v250, v137 row_newbcast:2 row_mask:0xf bank_mask:0xf
    v_fmac_f32_dpp v246, v250, v138 row_newbcast:2 row_mask:0xf bank_mask:0xf
    v_fmac_f32_dpp v247, v250, v139 row_newbcast:2 row_mask:0xf bank_mask:0xf
    v_fmac_f32_dpp v244, v250, v140 row_newbcast:3 row_mask:0xf bank_mask:0xf
    v_fmac_f32_dpp v245, v250, v141 row_newbcast:3 row_mask:0xf bank_mask:0xf
    v_fmac_f32_dpp v246, v250, v142 row_newbcast:3 row_mask:0xf bank_mask:0xf
    v_fmac_f32_dpp v247, v250, v143 row_newbcast:3 row_mask:0xf bank_mask:0xf
    v_fmac_f32_dpp v244, v250, v144 row_newbcast:4 row_mask:0xf bank_mask:0xf
    v_fmac_f32_dpp v245, v250, v145 row_newbcast:4 row_mask:0xf bank_mask:0xf
    v_fmac_f32_dpp v246, v250, v146 row_newbcast:4 row_mask:0xf bank_mask:0xf
    v_fmac_f32_dpp v247, v250, v147 row_newbcast:4 row_mask:0xf bank_mask:0xf
    v_fmac_f32_dpp v244, v250, v148 row_newbcast:5 row_mask:0xf bank_mask:0xf
    v_fmac_f32_dpp v245, v250, v149 row_newbcast:5 row_mask:0xf bank_mask:0xf
    v_fmac_f32_dpp v246, v250, v150 row_newbcast:5 row_mask:0xf bank_mask:0xf
    v_fmac_f32_dpp v247, v250, v151 row_newbcast:5 row_mask:0xf bank_mask:0xf
    v_fmac_f32_dpp v244, v250, v152 row_newbcast:6 row_mask:0xf bank_mask:0xf
    v_fmac_f32_dpp v245, v250, v153 row_newbcast:6 row_mask:0xf bank_mask:0xf
    v_fmac_f32_dpp v246, v250, v154 row_newbcast:6 row_mask:0xf bank_mask:0xf
    v_fmac_f32_dpp v247, v250, v155 row_newbcast:6 row_mask:0xf bank_mask:0xf
    v_fmac_f32_dpp v244, v250, v156 row_newbcast:7 row_mask:0xf bank_mask:0xf
    v_fmac_f32_dpp v245, v250, v157 row_newbcast:7 row_mask:0xf bank_mask:0xf
    v_fmac_f32_dpp v246, v250, v158 row_newbcast:7 row_mask:0xf bank_mask:0xf
    v_fmac_f32_dpp v247, v250, v159 row_newbcast:7 row_mask:0xf bank_mask:0xf
    s_lshl_b32 s28, s40, 11
    s_lshl_b32 s29, s4, 16
    s_add_u32 s28, s28, s29
    s_add_u32 s28, s28, 2621440
    s_mov_b64 exec, s[36:37]

    s_cmp_eq_u32 s7, 0
    s_cbranch_scc1 L_slow_80
    buffer_store_dwordx4 v[244:247], v3, s[8:11], s28 offen
    s_branch L_pubd_81
L_slow_80:
    buffer_store_dwordx4 v[244:247], v3, s[8:11], s28 offen sc1
L_pubd_81:

    s_mov_b64 exec, -1
L_noffn_79:
    s_cmp_lg_u32 s35, 2
    s_cbranch_scc1 L_only_82

    s_lshl_b32 s28, s4, 10
    s_add_u32 s28, s28, 139264
    s_mov_b64 exec, s[36:37]

    s_mov_b32 s34, 0
L_poll_83:
    buffer_load_dwordx4 v[176:179], v6, s[8:11], s28 offen sc1
    s_waitcnt vmcnt(0)
    v_max3_u32 v250, v176, v177, v178
    v_max_u32 v250, v250, v179
    v_cmp_eq_u32 vcc, -1, v250
    s_cmp_eq_u64 vcc, 0
    s_cbranch_scc1 L_polld_84

    s_add_u32 s34, s34, 1
    s_cmp_lt_u32 s34, 100000
    s_cbranch_scc1 L_poll_83
L_polld_84:

    ds_write_b128 v6, v[176:179] offset:2048
    s_mov_b64 exec, -1
    s_waitcnt lgkmcnt(0)

L_only_82:
    s_barrier
    s_cmp_ge_u32 s35, 2
    s_cbranch_scc1 L_noq_85

    v_mov_b32 v244, 0
    v_mov_b32 v245, 0
    v_mov_b32 v246, 0
    v_mov_b32 v247, 0
    s_mov_b64 exec, s[36:37]
    ds_read_b128 v[244:247], v6 offset:2048
    s_mov_b64 exec, -1

    ds_read_b128 v[176:179], v5 offset:2048
    ds_read_b128 v[180:183], v5 offset:2112
    ds_read_b128 v[184:187], v5 offset:2176
    ds_read_b128 v[188:191], v5 offset:2240
    ds_read_b128 v[192:195], v5 offset:2304
    ds_read_b128 v[196:199], v5 offset:2368
    ds_read_b128 v[200:203], v5 offset:2432
    ds_read_b128 v[204:207], v5 offset:2496
    ds_read_b128 v[208:211], v5 offset:2560
    ds_read_b128 v[212:215], v5 offset:2624
    ds_read_b128 v[216:219], v5 offset:2688
    ds_read_b128 v[220:223], v5 offset:2752
    ds_read_b128 v[224:227], v5 offset:2816
    ds_read_b128 v[228:231], v5 offset:2880
    s_waitcnt lgkmcnt(14)
    s_waitcnt lgkmcnt(13)
    v_mfma_f32_16x16x32_bf16 v[232:235], v[176:179], v[72:75], 0
    v_dot2_f32_bf16 v248, v244, v240, 0
    v_dot2_f32_bf16 v249, v244, v244, 0
    v_dot2_f32_bf16 v248, v245, v240, v248
    s_waitcnt lgkmcnt(12)
    v_mfma_f32_16x16x32_bf16 v[232:235], v[180:183], v[76:79], v[232:235]
    v_dot2_f32_bf16 v249, v245, v245, v249
    v_dot2_f32_bf16 v248, v246, v240, v248
    v_dot2_f32_bf16 v249, v246, v246, v249
    s_waitcnt lgkmcnt(11)
    v_mfma_f32_16x16x32_bf16 v[232:235], v[184:187], v[80:83], v[232:235]
    v_dot2_f32_bf16 v248, v247, v240, v248
    v_dot2_f32_bf16 v249, v247, v247, v249
    s_nop 2
    s_waitcnt lgkmcnt(10)
    v_mfma_f32_16x16x32_bf16 v[232:235], v[188:191], v[84:87], v[232:235]
    v_add_f32_dpp v248, v248, v248 row_shr:1 row_mask:0xf bank_mask:0xf bound_ctrl:0
    v_add_f32_dpp v249, v249, v249 row_shr:1 row_mask:0xf bank_mask:0xf bound_ctrl:0
    s_nop 0
    s_waitcnt lgkmcnt(9)
    v_mfma_f32_16x16x32_bf16 v[232:235], v[192:195], v[88:91], v[232:235]
    v_add_f32_dpp v248, v248, v248 row_shr:2 row_mask:0xf bank_mask:0xf bound_ctrl:0
    v_add_f32_dpp v249, v249, v249 row_shr:2 row_mask:0xf bank_mask:0xf bound_ctrl:0
    s_nop 0
    s_waitcnt lgkmcnt(8)
    v_mfma_f32_16x16x32_bf16 v[232:235], v[196:199], v[92:95], v[232:235]
    v_add_f32_dpp v248, v248, v248 row_shr:4 row_mask:0xf bank_mask:0xf bound_ctrl:0
    v_add_f32_dpp v249, v249, v249 row_shr:4 row_mask:0xf bank_mask:0xf bound_ctrl:0
    s_nop 0
    s_waitcnt lgkmcnt(7)
    v_mfma_f32_16x16x32_bf16 v[232:235], v[200:203], v[96:99], v[232:235]
    v_add_f32_dpp v248, v248, v248 row_shr:8 row_mask:0xf bank_mask:0xf bound_ctrl:0
    v_add_f32_dpp v249, v249, v249 row_shr:8 row_mask:0xf bank_mask:0xf bound_ctrl:0
    s_nop 0
    s_waitcnt lgkmcnt(6)
    v_mfma_f32_16x16x32_bf16 v[232:235], v[204:207], v[100:103], v[232:235]
    v_add_f32_dpp v248, v248, v248 row_bcast:15 row_mask:0xa bank_mask:0xf
    v_add_f32_dpp v249, v249, v249 row_bcast:15 row_mask:0xa bank_mask:0xf
    s_nop 0
    s_waitcnt lgkmcnt(5)
    v_mfma_f32_16x16x32_bf16 v[232:235], v[208:211], v[104:107], v[232:235]
    v_add_f32_dpp v248, v248, v248 row_bcast:31 row_mask:0xc bank_mask:0xf
    v_add_f32_dpp v249, v249, v249 row_bcast:31 row_mask:0xc bank_mask:0xf
    s_nop 0
    s_waitcnt lgkmcnt(4)
    v_mfma_f32_16x16x32_bf16 v[232:235], v[212:215], v[108:111], v[232:235]
    v_readlane_b32 s46, v248, 63
    v_readlane_b32 s47, v249, 63
    v_mov_b32 v250, s45
    s_nop 0
    s_waitcnt lgkmcnt(3)
    v_mfma_f32_16x16x32_bf16 v[232:235], v[216:219], v[112:115], v[232:235]
    v_mul_f32 v251, s46, v250
    v_mul_f32 v252, s47, v250
    v_fma_f32 v252, -v251, v251, v252
    v_max_f32 v252, 0, v252
    s_waitcnt lgkmcnt(2)
    v_mfma_f32_16x16x32_bf16 v[232:235], v[220:223], v[116:119], v[232:235]
    v_add_f32 v252, s48, v252
    v_rsq_f32 v252, v252
    s_waitcnt lgkmcnt(1)
    v_mfma_f32_16x16x32_bf16 v[232:235], v[224:227], v[120:123], v[232:235]
    s_waitcnt lgkmcnt(0)
    v_mfma_f32_16x16x32_bf16 v[232:235], v[228:231], v[124:127], v[232:235]
    s_nop 7
    v_fma_f32 v254, -v251, v237, v232
    v_mul_f32 v254, v254, v252

    s_nop 1
    v_mov_b32_dpp v253, v254 quad_perm:[1,0,3,2] row_mask:0xf bank_mask:0xf
    v_mov_b32 v15, s6
    v_cvt_pk_bf16_f32 v14, v254, v253
    v_lshlrev_b32 v250, 2, v0
    s_lshl_b32 s28, s4, 11
    s_lshl_b32 s29, s40, 6
    s_add_u32 s28, s28, s29
    s_add_u32 s28, s28, 24576
    s_mov_b64 exec, 0x5555

    s_cmp_eq_u32 s7, 0
    s_cbranch_scc1 L_slow_86
    buffer_store_dwordx2 v[14:15], v250, s[8:11], s28 offen
    s_branch L_pubd_87
L_slow_86:
    buffer_store_dwordx2 v[14:15], v250, s[8:11], s28 offen sc1
L_pubd_87:

    s_mov_b64 exec, -1
L_noq_85:
    s_barrier
    s_cmp_ge_u32 s5, 30
    s_cbranch_scc1 L_wend_18

    s_cmp_ge_u32 s5, 30
    s_cbranch_scc1 L_nox_88

    s_cmp_lg_u32 s35, 2
    s_cbranch_scc1 L_only_89

    s_lshl_b32 s28, s4, 10
    s_add_u32 s28, s28, 147456
    s_mov_b64 exec, s[36:37]

    s_mov_b32 s34, 0
L_poll_90:
    buffer_load_dwordx4 v[176:179], v6, s[8:11], s28 offen sc1
    s_waitcnt vmcnt(0)
    v_max3_u32 v250, v176, v177, v178
    v_max_u32 v250, v250, v179
    v_cmp_eq_u32 vcc, -1, v250
    s_cmp_eq_u64 vcc, 0
    s_cbranch_scc1 L_polld_91

    s_add_u32 s34, s34, 1
    s_cmp_lt_u32 s34, 100000
    s_cbranch_scc1 L_poll_90
L_polld_91:

    ds_write_b128 v6, v[176:179] offset:3072
    s_mov_b64 exec, -1
    s_waitcnt lgkmcnt(0)

L_only_89:
L_nox_88:
    s_barrier
    s_cmp_ge_u32 s5, 30
    s_cbranch_scc1 L_noffn_92

    v_mov_b32 v244, 0
    v_mov_b32 v245, 0
    v_mov_b32 v246, 0
    v_mov_b32 v247, 0
    s_mov_b64 exec, s[36:37]
    ds_read_b128 v[244:247], v6 offset:3072
    s_mov_b64 exec, -1

    ds_read_b128 v[176:179], v5 offset:3072
    ds_read_b128 v[180:183], v5 offset:3136
    ds_read_b128 v[184:187], v5 offset:3200
    ds_read_b128 v[188:191], v5 offset:3264
    ds_read_b128 v[192:195], v5 offset:3328
    ds_read_b128 v[196:199], v5 offset:3392
    ds_read_b128 v[200:203], v5 offset:3456
    ds_read_b128 v[204:207], v5 offset:3520
    ds_read_b128 v[208:211], v5 offset:3584
    ds_read_b128 v[212:215], v5 offset:3648
    ds_read_b128 v[216:219], v5 offset:3712
    ds_read_b128 v[220:223], v5 offset:3776
    ds_read_b128 v[224:227], v5 offset:3840
    ds_read_b128 v[228:231], v5 offset:3904
    s_waitcnt lgkmcnt(14)
    s_waitcnt lgkmcnt(13)
    v_mfma_f32_16x16x32_bf16 v[232:235], v[176:179], v[16:19], 0
    v_dot2_f32_bf16 v248, v244, v240, 0
    v_dot2_f32_bf16 v249, v244, v244, 0
    v_dot2_f32_bf16 v248, v245, v240, v248
    s_waitcnt lgkmcnt(12)
    v_mfma_f32_16x16x32_bf16 v[232:235], v[180:183], v[20:23], v[232:235]
    v_dot2_f32_bf16 v249, v245, v245, v249
    v_dot2_f32_bf16 v248, v246, v240, v248
    v_dot2_f32_bf16 v249, v246, v246, v249
    s_waitcnt lgkmcnt(11)
    v_mfma_f32_16x16x32_bf16 v[232:235], v[184:187], v[24:27], v[232:235]
    v_dot2_f32_bf16 v248, v247, v240, v248
    v_dot2_f32_bf16 v249, v247, v247, v249
    s_nop 2
    s_waitcnt lgkmcnt(10)
    v_mfma_f32_16x16x32_bf16 v[232:235], v[188:191], v[28:31], v[232:235]
    v_add_f32_dpp v248, v248, v248 row_shr:1 row_mask:0xf bank_mask:0xf bound_ctrl:0
    v_add_f32_dpp v249, v249, v249 row_shr:1 row_mask:0xf bank_mask:0xf bound_ctrl:0
    s_nop 0
    s_waitcnt lgkmcnt(9)
    v_mfma_f32_16x16x32_bf16 v[232:235], v[192:195], v[32:35], v[232:235]
    v_add_f32_dpp v248, v248, v248 row_shr:2 row_mask:0xf bank_mask:0xf bound_ctrl:0
    v_add_f32_dpp v249, v249, v249 row_shr:2 row_mask:0xf bank_mask:0xf bound_ctrl:0
    s_nop 0
    s_waitcnt lgkmcnt(8)
    v_mfma_f32_16x16x32_bf16 v[232:235], v[196:199], v[36:39], v[232:235]
    v_add_f32_dpp v248, v248, v248 row_shr:4 row_mask:0xf bank_mask:0xf bound_ctrl:0
    v_add_f32_dpp v249, v249, v249 row_shr:4 row_mask:0xf bank_mask:0xf bound_ctrl:0
    s_nop 0
    s_waitcnt lgkmcnt(7)
    v_mfma_f32_16x16x32_bf16 v[232:235], v[200:203], v[40:43], v[232:235]
    v_add_f32_dpp v248, v248, v248 row_shr:8 row_mask:0xf bank_mask:0xf bound_ctrl:0
    v_add_f32_dpp v249, v249, v249 row_shr:8 row_mask:0xf bank_mask:0xf bound_ctrl:0
    s_nop 0
    s_waitcnt lgkmcnt(6)
    v_mfma_f32_16x16x32_bf16 v[232:235], v[204:207], v[44:47], v[232:235]
    v_add_f32_dpp v248, v248, v248 row_bcast:15 row_mask:0xa bank_mask:0xf
    v_add_f32_dpp v249, v249, v249 row_bcast:15 row_mask:0xa bank_mask:0xf
    s_nop 0
    s_waitcnt lgkmcnt(5)
    v_mfma_f32_16x16x32_bf16 v[232:235], v[208:211], v[48:51], v[232:235]
    v_add_f32_dpp v248, v248, v248 row_bcast:31 row_mask:0xc bank_mask:0xf
    v_add_f32_dpp v249, v249, v249 row_bcast:31 row_mask:0xc bank_mask:0xf
    s_nop 0
    s_waitcnt lgkmcnt(4)
    v_mfma_f32_16x16x32_bf16 v[232:235], v[212:215], v[52:55], v[232:235]
    v_readlane_b32 s46, v248, 63
    v_readlane_b32 s47, v249, 63
    v_mov_b32 v250, s45
    s_nop 0
    s_waitcnt lgkmcnt(3)
    v_mfma_f32_16x16x32_bf16 v[232:235], v[216:219], v[56:59], v[232:235]
    v_mul_f32 v251, s46, v250
    v_mul_f32 v252, s47, v250
    v_fma_f32 v252, -v251, v251, v252
    v_max_f32 v252, 0, v252
    s_waitcnt lgkmcnt(2)
    v_mfma_f32_16x16x32_bf16 v[232:235], v[220:223], v[60:63], v[232:235]
    v_add_f32 v252, s48, v252
    v_rsq_f32 v252, v252
    s_waitcnt lgkmcnt(1)
    v_mfma_f32_16x16x32_bf16 v[232:235], v[224:227], v[64:67], v[232:235]
    s_waitcnt lgkmcnt(0)
    v_mfma_f32_16x16x32_bf16 v[232:235], v[228:231], v[68:71], v[232:235]
    s_nop 7
    v_fma_f32 v254, -v251, v236, v232
    v_mul_f32 v254, v254, v252

    v_mul_f32 v250, s49, v254
    v_exp_f32 v250, v250
    v_mov_b32_dpp v253, v254 row_ror:8 row_mask:0xf bank_mask:0xf
    v_add_f32 v250, 1.0, v250
    v_rcp_f32 v250, v250
    s_nop 0
    v_mul_f32 v250, v250, v254

    v_mul_f32 v250, v250, v253
    v_mov_b32 v244, 0
    v_mov_b32 v245, 0
    v_mov_b32 v246, 0
    v_mov_b32 v247, 0

    v_fmac_f32_dpp v244, v250, v128 row_newbcast:0 row_mask:0xf bank_mask:0xf
    v_fmac_f32_dpp v245, v250, v129 row_newbcast:0 row_mask:0xf bank_mask:0xf
    v_fmac_f32_dpp v246, v250, v130 row_newbcast:0 row_mask:0xf bank_mask:0xf
    v_fmac_f32_dpp v247, v250, v131 row_newbcast:0 row_mask:0xf bank_mask:0xf
    v_fmac_f32_dpp v244, v250, v132 row_newbcast:1 row_mask:0xf bank_mask:0xf
    v_fmac_f32_dpp v245, v250, v133 row_newbcast:1 row_mask:0xf bank_mask:0xf
    v_fmac_f32_dpp v246, v250, v134 row_newbcast:1 row_mask:0xf bank_mask:0xf
    v_fmac_f32_dpp v247, v250, v135 row_newbcast:1 row_mask:0xf bank_mask:0xf
    v_fmac_f32_dpp v244, v250, v136 row_newbcast:2 row_mask:0xf bank_mask:0xf
    v_fmac_f32_dpp v245, v250, v137 row_newbcast:2 row_mask:0xf bank_mask:0xf
    v_fmac_f32_dpp v246, v250, v138 row_newbcast:2 row_mask:0xf bank_mask:0xf
    v_fmac_f32_dpp v247, v250, v139 row_newbcast:2 row_mask:0xf bank_mask:0xf
    v_fmac_f32_dpp v244, v250, v140 row_newbcast:3 row_mask:0xf bank_mask:0xf
    v_fmac_f32_dpp v245, v250, v141 row_newbcast:3 row_mask:0xf bank_mask:0xf
    v_fmac_f32_dpp v246, v250, v142 row_newbcast:3 row_mask:0xf bank_mask:0xf
    v_fmac_f32_dpp v247, v250, v143 row_newbcast:3 row_mask:0xf bank_mask:0xf
    v_fmac_f32_dpp v244, v250, v144 row_newbcast:4 row_mask:0xf bank_mask:0xf
    v_fmac_f32_dpp v245, v250, v145 row_newbcast:4 row_mask:0xf bank_mask:0xf
    v_fmac_f32_dpp v246, v250, v146 row_newbcast:4 row_mask:0xf bank_mask:0xf
    v_fmac_f32_dpp v247, v250, v147 row_newbcast:4 row_mask:0xf bank_mask:0xf
    v_fmac_f32_dpp v244, v250, v148 row_newbcast:5 row_mask:0xf bank_mask:0xf
    v_fmac_f32_dpp v245, v250, v149 row_newbcast:5 row_mask:0xf bank_mask:0xf
    v_fmac_f32_dpp v246, v250, v150 row_newbcast:5 row_mask:0xf bank_mask:0xf
    v_fmac_f32_dpp v247, v250, v151 row_newbcast:5 row_mask:0xf bank_mask:0xf
    v_fmac_f32_dpp v244, v250, v152 row_newbcast:6 row_mask:0xf bank_mask:0xf
    v_fmac_f32_dpp v245, v250, v153 row_newbcast:6 row_mask:0xf bank_mask:0xf
    v_fmac_f32_dpp v246, v250, v154 row_newbcast:6 row_mask:0xf bank_mask:0xf
    v_fmac_f32_dpp v247, v250, v155 row_newbcast:6 row_mask:0xf bank_mask:0xf
    v_fmac_f32_dpp v244, v250, v156 row_newbcast:7 row_mask:0xf bank_mask:0xf
    v_fmac_f32_dpp v245, v250, v157 row_newbcast:7 row_mask:0xf bank_mask:0xf
    v_fmac_f32_dpp v246, v250, v158 row_newbcast:7 row_mask:0xf bank_mask:0xf
    v_fmac_f32_dpp v247, v250, v159 row_newbcast:7 row_mask:0xf bank_mask:0xf
    s_lshl_b32 s28, s40, 11
    s_lshl_b32 s29, s4, 16
    s_add_u32 s28, s28, s29
    s_add_u32 s28, s28, 3670016
    s_mov_b64 exec, s[36:37]

    s_cmp_eq_u32 s7, 0
    s_cbranch_scc1 L_slow_93
    buffer_store_dwordx4 v[244:247], v3, s[8:11], s28 offen
    s_branch L_pubd_94
L_slow_93:
    buffer_store_dwordx4 v[244:247], v3, s[8:11], s28 offen sc1
L_pubd_94:

    s_mov_b64 exec, -1
L_noffn_92:
L_wend_18:
    s_endpgm
L_exit:
    s_endpgm
.section .rodata,"a"
.p2align 6
.amdhsa_kernel interleave_layers__sliding_block_cached__swiglu_ffn__decode_kernel
  .amdhsa_next_free_vgpr 256
  .amdhsa_next_free_sgpr 102
  .amdhsa_accum_offset 256
  .amdhsa_group_segment_fixed_size 0
  .amdhsa_kernarg_size 96
  .amdhsa_user_sgpr_count 2
  .amdhsa_user_sgpr_kernarg_segment_ptr 1
  .amdhsa_system_sgpr_workgroup_id_x 1
  .amdhsa_float_denorm_mode_32 3
.end_amdhsa_kernel
```
